```python
import torch

def _softmax(x, axis=-1):
    return torch.softmax(x, dim=axis)
def _gelu(x):
    return torch.nn.functional.gelu(x, approximate="tanh")
def _silu(x):
    return torch.nn.functional.silu(x)
def _sigmoid(x):
    return torch.sigmoid(x)
def _layernorm(x, axis=-1, eps=1e-5):
    m = x.mean(dim=axis, keepdim=True)
    v = x.var(dim=axis, keepdim=True, unbiased=False)
    return (x - m) / torch.sqrt(v + eps)
def _scatter_add(tgt, idx, src, axis=0):
    return tgt.clone().index_add_(axis, idx, src)
def _segment_sum(src, seg, n):
    out = torch.zeros((n,) + src.shape[1:], dtype=src.dtype)
    return out.index_add_(0, seg, src)
def _pad(x, pw):
    flat = tuple(v for pair in reversed(pw) for v in pair)
    return torch.nn.functional.pad(x, flat)

kernel_name = 'parallel_sum__sliding_local_dilated__glu_gated_reglu__prompt'

def setup_inputs():

    _w = (lambda a: (lambda t: t.to(torch.bfloat16) if t.is_floating_point() else t)(torch.as_tensor(a)))
    def _A_setup():
        B, S, D = 1, 2048, 640
        return {
            "x": _w((lambda *s: torch.randn(*s, dtype=torch.bfloat16) * 0.05)(B, S, D)),
            "wqkv": _w((lambda *s: torch.randn(*s, dtype=torch.bfloat16) * 0.05)(D, 3 * D)),
            "wo": _w((lambda *s: torch.randn(*s, dtype=torch.bfloat16) * 0.05)(D, D)),
        }
    _A_in = _A_setup()

    def _B_setup():
        B, S, D, F = 1, 2048, 640, 1728
        return {
            "x": _w((lambda *s: torch.randn(*s, dtype=torch.bfloat16) * 0.05)(B, S, D)),
            "W_gate": _w((lambda *s: torch.randn(*s, dtype=torch.bfloat16) * 0.8)(D, F) * (2.0 / D) ** 0.5),
            "W_up": _w((lambda *s: torch.randn(*s, dtype=torch.bfloat16) * 0.8)(D, F) * (2.0 / D) ** 0.5),
            "W_down": _w((lambda *s: torch.randn(*s, dtype=torch.bfloat16) * 0.8)(F, D) * (1.0 / F) ** 0.5),
        }
    _B_in = _B_setup()

    return {
        "A_x": _A_in["x"],
        "A_wqkv": _A_in["wqkv"],
        "A_wo": _A_in["wo"],
        "B_x": _B_in["x"],
        "B_W_gate": _B_in["W_gate"],
        "B_W_up": _B_in["W_up"],
        "B_W_down": _B_in["W_down"],
    }

def reference(A_x, A_wqkv, A_wo, B_x, B_W_gate, B_W_up, B_W_down):
    def _A_ref(x, wqkv, wo):
        B, S, D = x.shape
        H = 32; Dh = D // H
        W, dil = 8, 2
        qkv = (lambda x, *d: x.permute(*d))((x @ wqkv).reshape(B, S, 3, H, Dh), 2, 0, 3, 1, 4)
        q, k, v = qkv[0], qkv[1], qkv[2]
        scale = Dh ** -0.5
        pos = torch.arange(S)
        off = torch.arange(W) * dil
        idx = pos[:, None] - off[None, :]
        mask = idx >= 0
        idx_c = torch.where(mask, idx, 0).reshape(-1)
        kg = k[:, :, idx_c, :].reshape(B, H, S, W, Dh)
        vg = v[:, :, idx_c, :].reshape(B, H, S, W, Dh)
        logits = torch.einsum("bhsd,bhswd->bhsw", q, kg) * scale
        logits = torch.where(mask[None, None, :, :], logits, -1e9)
        attn = _softmax(logits, axis=-1)
        o = torch.einsum("bhsw,bhswd->bhsd", attn, vg)
        return (lambda x, *d: x.permute(*d))(o, 0, 2, 1, 3).reshape(B, S, D) @ wo

    def _B_ref(x, W_gate, W_up, W_down):
        gate = torch.einsum("bsd,df->bsf", x, W_gate)
        up = torch.einsum("bsd,df->bsf", x, W_up)
        gate = gate * (lambda x, dt: x.to(dt))(gate > 0, gate.dtype)
        h = gate * up
        return torch.einsum("bsf,fd->bsd", h, W_down)

    x = A_x
    xn = _layernorm(x, axis=-1)
    return x + _A_ref(xn, A_wqkv, A_wo) + _B_ref(xn, B_W_gate, B_W_up, B_W_down)
```

```asm
; @launch kernel=k1_prep_kernel grid=(516,1,1) block=(256,1,1) lds=2048
; @launch kernel=k2_gemm1_kernel grid=(224,1,1) block=(768,1,1) lds=143360
; @launch kernel=k3_attn_kernel grid=(256,1,1) block=(256,1,1) lds=0
; @launch kernel=k4_gemm2_kernel grid=(256,1,1) block=(256,1,1) lds=81920
.amdgcn_target "amdgcn-amd-amdhsa--gfx950"
.text
.p2align 8
.globl k1_prep_kernel
.type k1_prep_kernel,@function
k1_prep_kernel:
    s_cmp_ge_u32 s2, 516
    s_cbranch_scc1 L_k1_end
    s_load_dwordx4 s[4:7], s[0:1], 0
    s_load_dwordx2 s[8:9], s[0:1], 16
    s_load_dwordx4 s[12:15], s[0:1], 32
    s_load_dwordx2 s[16:17], s[0:1], 48
    s_load_dwordx2 s[18:19], s[0:1], 72
    s_waitcnt lgkmcnt(0)
    s_cmp_lt_u32 s2, 128
    s_cbranch_scc1 L_k1_ln
    s_sub_u32 s20, s2, 128
    s_cmp_lt_u32 s20, 80
    s_cbranch_scc1 L_k1_qkv
    s_sub_u32 s20, s20, 80
    s_cmp_lt_u32 s20, 80
    s_cbranch_scc1 L_k1_g
    s_sub_u32 s20, s20, 80
    s_cmp_lt_u32 s20, 80
    s_cbranch_scc1 L_k1_u
    s_sub_u32 s20, s20, 80
    s_cmp_lt_u32 s20, 40
    s_cbranch_scc1 L_k1_wo
    s_sub_u32 s20, s20, 40
    s_branch L_k1_wd
L_k1_qkv:
    v_cmp_gt_u32 vcc, 240, v0
    s_and_saveexec_b64 s[30:31], vcc
    s_cbranch_execz L_k1_end
    v_mov_b32 v1, v0
    s_mul_i32 s21, s20, 30720
    s_add_u32 s22, s6, s21
    s_addc_u32 s23, s7, 0
    v_lshlrev_b32 v2, 4, v1
    global_load_dwordx4 v[8:11], v2, s[22:23]
    s_add_u32 s22, s22, 3840
    s_addc_u32 s23, s23, 0
    global_load_dwordx4 v[12:15], v2, s[22:23]
    s_add_u32 s22, s22, 3840
    s_addc_u32 s23, s23, 0
    global_load_dwordx4 v[16:19], v2, s[22:23]
    s_add_u32 s22, s22, 3840
    s_addc_u32 s23, s23, 0
    global_load_dwordx4 v[20:23], v2, s[22:23]
    s_add_u32 s22, s22, 3840
    s_addc_u32 s23, s23, 0
    global_load_dwordx4 v[24:27], v2, s[22:23]
    s_add_u32 s22, s22, 3840
    s_addc_u32 s23, s23, 0
    global_load_dwordx4 v[28:31], v2, s[22:23]
    s_add_u32 s22, s22, 3840
    s_addc_u32 s23, s23, 0
    global_load_dwordx4 v[32:35], v2, s[22:23]
    s_add_u32 s22, s22, 3840
    s_addc_u32 s23, s23, 0
    global_load_dwordx4 v[36:39], v2, s[22:23]
    v_lshrrev_b32 v4, 2, v1
    v_mul_u32_u24 v4, 40960, v4
    v_and_b32 v5, 3, v1
    v_lshlrev_b32 v5, 6, v5
    v_add_u32 v4, v4, v5
    v_add_u32 v5, 20480, v4
    s_lshr_b32 s21, s20, 2
    s_lshl_b32 s21, s21, 10
    s_and_b32 s24, s20, 3
    s_lshl_b32 s24, s24, 8
    s_add_u32 s21, s21, s24
    s_add_u32 s24, s18, 0x400000
    s_addc_u32 s25, s19, 0
    s_add_u32 s24, s24, s21
    s_addc_u32 s25, s25, 0
    s_mov_b32 s26, 0x05040100
    s_mov_b32 s27, 0x07060302
    s_waitcnt vmcnt(0)
    v_perm_b32 v40, v12, v8, s26
    v_perm_b32 v41, v20, v16, s26
    v_perm_b32 v42, v28, v24, s26
    v_perm_b32 v43, v36, v32, s26
    global_store_dwordx4 v4, v[40:43], s[24:25] offset:0
    s_nop 1
    v_perm_b32 v40, v12, v8, s27
    v_perm_b32 v41, v20, v16, s27
    v_perm_b32 v42, v28, v24, s27
    v_perm_b32 v43, v36, v32, s27
    global_store_dwordx4 v4, v[40:43], s[24:25] offset:16
    s_nop 1
    v_perm_b32 v40, v13, v9, s26
    v_perm_b32 v41, v21, v17, s26
    v_perm_b32 v42, v29, v25, s26
    v_perm_b32 v43, v37, v33, s26
    global_store_dwordx4 v4, v[40:43], s[24:25] offset:32
    s_nop 1
    v_perm_b32 v40, v13, v9, s27
    v_perm_b32 v41, v21, v17, s27
    v_perm_b32 v42, v29, v25, s27
    v_perm_b32 v43, v37, v33, s27
    global_store_dwordx4 v4, v[40:43], s[24:25] offset:48
    s_nop 1
    v_perm_b32 v40, v14, v10, s26
    v_perm_b32 v41, v22, v18, s26
    v_perm_b32 v42, v30, v26, s26
    v_perm_b32 v43, v38, v34, s26
    global_store_dwordx4 v5, v[40:43], s[24:25] offset:0
    s_nop 1
    v_perm_b32 v40, v14, v10, s27
    v_perm_b32 v41, v22, v18, s27
    v_perm_b32 v42, v30, v26, s27
    v_perm_b32 v43, v38, v34, s27
    global_store_dwordx4 v5, v[40:43], s[24:25] offset:16
    s_nop 1
    v_perm_b32 v40, v15, v11, s26
    v_perm_b32 v41, v23, v19, s26
    v_perm_b32 v42, v31, v27, s26
    v_perm_b32 v43, v39, v35, s26
    global_store_dwordx4 v5, v[40:43], s[24:25] offset:32
    s_nop 1
    v_perm_b32 v40, v15, v11, s27
    v_perm_b32 v41, v23, v19, s27
    v_perm_b32 v42, v31, v27, s27
    v_perm_b32 v43, v39, v35, s27
    global_store_dwordx4 v5, v[40:43], s[24:25] offset:48
    s_nop 1
    s_branch L_k1_end
L_k1_g:
    v_cmp_gt_u32 vcc, 216, v0
    s_and_saveexec_b64 s[30:31], vcc
    s_cbranch_execz L_k1_end
    v_mov_b32 v1, v0
    s_mul_i32 s21, s20, 27648
    s_add_u32 s22, s12, s21
    s_addc_u32 s23, s13, 0
    v_lshlrev_b32 v2, 4, v1
    global_load_dwordx4 v[8:11], v2, s[22:23]
    s_add_u32 s22, s22, 3456
    s_addc_u32 s23, s23, 0
    global_load_dwordx4 v[12:15], v2, s[22:23]
    s_add_u32 s22, s22, 3456
    s_addc_u32 s23, s23, 0
    global_load_dwordx4 v[16:19], v2, s[22:23]
    s_add_u32 s22, s22, 3456
    s_addc_u32 s23, s23, 0
    global_load_dwordx4 v[20:23], v2, s[22:23]
    s_add_u32 s22, s22, 3456
    s_addc_u32 s23, s23, 0
    global_load_dwordx4 v[24:27], v2, s[22:23]
    s_add_u32 s22, s22, 3456
    s_addc_u32 s23, s23, 0
    global_load_dwordx4 v[28:31], v2, s[22:23]
    s_add_u32 s22, s22, 3456
    s_addc_u32 s23, s23, 0
    global_load_dwordx4 v[32:35], v2, s[22:23]
    s_add_u32 s22, s22, 3456
    s_addc_u32 s23, s23, 0
    global_load_dwordx4 v[36:39], v2, s[22:23]
    v_lshrrev_b32 v4, 2, v1
    v_mul_u32_u24 v4, 81920, v4
    v_and_b32 v5, 3, v1
    v_lshlrev_b32 v5, 6, v5
    v_add_u32 v4, v4, v5
    v_add_u32 v5, 20480, v4
    s_lshr_b32 s21, s20, 2
    s_lshl_b32 s21, s21, 10
    s_and_b32 s24, s20, 3
    s_lshl_b32 s24, s24, 8
    s_add_u32 s21, s21, s24
    s_add_u32 s24, s18, 0x658000
    s_addc_u32 s25, s19, 0
    s_add_u32 s24, s24, s21
    s_addc_u32 s25, s25, 0
    s_mov_b32 s26, 0x05040100
    s_mov_b32 s27, 0x07060302
    s_waitcnt vmcnt(0)
    v_perm_b32 v40, v12, v8, s26
    v_perm_b32 v41, v20, v16, s26
    v_perm_b32 v42, v28, v24, s26
    v_perm_b32 v43, v36, v32, s26
    global_store_dwordx4 v4, v[40:43], s[24:25] offset:0
    s_nop 1
    v_perm_b32 v40, v12, v8, s27
    v_perm_b32 v41, v20, v16, s27
    v_perm_b32 v42, v28, v24, s27
    v_perm_b32 v43, v36, v32, s27
    global_store_dwordx4 v4, v[40:43], s[24:25] offset:16
    s_nop 1
    v_perm_b32 v40, v13, v9, s26
    v_perm_b32 v41, v21, v17, s26
    v_perm_b32 v42, v29, v25, s26
    v_perm_b32 v43, v37, v33, s26
    global_store_dwordx4 v4, v[40:43], s[24:25] offset:32
    s_nop 1
    v_perm_b32 v40, v13, v9, s27
    v_perm_b32 v41, v21, v17, s27
    v_perm_b32 v42, v29, v25, s27
    v_perm_b32 v43, v37, v33, s27
    global_store_dwordx4 v4, v[40:43], s[24:25] offset:48
    s_nop 1
    v_perm_b32 v40, v14, v10, s26
    v_perm_b32 v41, v22, v18, s26
    v_perm_b32 v42, v30, v26, s26
    v_perm_b32 v43, v38, v34, s26
    global_store_dwordx4 v5, v[40:43], s[24:25] offset:0
    s_nop 1
    v_perm_b32 v40, v14, v10, s27
    v_perm_b32 v41, v22, v18, s27
    v_perm_b32 v42, v30, v26, s27
    v_perm_b32 v43, v38, v34, s27
    global_store_dwordx4 v5, v[40:43], s[24:25] offset:16
    s_nop 1
    v_perm_b32 v40, v15, v11, s26
    v_perm_b32 v41, v23, v19, s26
    v_perm_b32 v42, v31, v27, s26
    v_perm_b32 v43, v39, v35, s26
    global_store_dwordx4 v5, v[40:43], s[24:25] offset:32
    s_nop 1
    v_perm_b32 v40, v15, v11, s27
    v_perm_b32 v41, v23, v19, s27
    v_perm_b32 v42, v31, v27, s27
    v_perm_b32 v43, v39, v35, s27
    global_store_dwordx4 v5, v[40:43], s[24:25] offset:48
    s_nop 1
    s_branch L_k1_end
L_k1_u:
    v_cmp_gt_u32 vcc, 216, v0
    s_and_saveexec_b64 s[30:31], vcc
    s_cbranch_execz L_k1_end
    v_mov_b32 v1, v0
    s_mul_i32 s21, s20, 27648
    s_add_u32 s22, s14, s21
    s_addc_u32 s23, s15, 0
    v_lshlrev_b32 v2, 4, v1
    global_load_dwordx4 v[8:11], v2, s[22:23]
    s_add_u32 s22, s22, 3456
    s_addc_u32 s23, s23, 0
    global_load_dwordx4 v[12:15], v2, s[22:23]
    s_add_u32 s22, s22, 3456
    s_addc_u32 s23, s23, 0
    global_load_dwordx4 v[16:19], v2, s[22:23]
    s_add_u32 s22, s22, 3456
    s_addc_u32 s23, s23, 0
    global_load_dwordx4 v[20:23], v2, s[22:23]
    s_add_u32 s22, s22, 3456
    s_addc_u32 s23, s23, 0
    global_load_dwordx4 v[24:27], v2, s[22:23]
    s_add_u32 s22, s22, 3456
    s_addc_u32 s23, s23, 0
    global_load_dwordx4 v[28:31], v2, s[22:23]
    s_add_u32 s22, s22, 3456
    s_addc_u32 s23, s23, 0
    global_load_dwordx4 v[32:35], v2, s[22:23]
    s_add_u32 s22, s22, 3456
    s_addc_u32 s23, s23, 0
    global_load_dwordx4 v[36:39], v2, s[22:23]
    v_lshrrev_b32 v4, 2, v1
    v_mul_u32_u24 v4, 81920, v4
    v_and_b32 v5, 3, v1
    v_lshlrev_b32 v5, 6, v5
    v_add_u32 v4, v4, v5
    v_add_u32 v5, 20480, v4
    s_lshr_b32 s21, s20, 2
    s_lshl_b32 s21, s21, 10
    s_and_b32 s24, s20, 3
    s_lshl_b32 s24, s24, 8
    s_add_u32 s21, s21, s24
    s_add_u32 s24, s18, 0x662000
    s_addc_u32 s25, s19, 0
    s_add_u32 s24, s24, s21
    s_addc_u32 s25, s25, 0
    s_mov_b32 s26, 0x05040100
    s_mov_b32 s27, 0x07060302
    s_waitcnt vmcnt(0)
    v_perm_b32 v40, v12, v8, s26
    v_perm_b32 v41, v20, v16, s26
    v_perm_b32 v42, v28, v24, s26
    v_perm_b32 v43, v36, v32, s26
    global_store_dwordx4 v4, v[40:43], s[24:25] offset:0
    s_nop 1
    v_perm_b32 v40, v12, v8, s27
    v_perm_b32 v41, v20, v16, s27
    v_perm_b32 v42, v28, v24, s27
    v_perm_b32 v43, v36, v32, s27
    global_store_dwordx4 v4, v[40:43], s[24:25] offset:16
    s_nop 1
    v_perm_b32 v40, v13, v9, s26
    v_perm_b32 v41, v21, v17, s26
    v_perm_b32 v42, v29, v25, s26
    v_perm_b32 v43, v37, v33, s26
    global_store_dwordx4 v4, v[40:43], s[24:25] offset:32
    s_nop 1
    v_perm_b32 v40, v13, v9, s27
    v_perm_b32 v41, v21, v17, s27
    v_perm_b32 v42, v29, v25, s27
    v_perm_b32 v43, v37, v33, s27
    global_store_dwordx4 v4, v[40:43], s[24:25] offset:48
    s_nop 1
    v_perm_b32 v40, v14, v10, s26
    v_perm_b32 v41, v22, v18, s26
    v_perm_b32 v42, v30, v26, s26
    v_perm_b32 v43, v38, v34, s26
    global_store_dwordx4 v5, v[40:43], s[24:25] offset:0
    s_nop 1
    v_perm_b32 v40, v14, v10, s27
    v_perm_b32 v41, v22, v18, s27
    v_perm_b32 v42, v30, v26, s27
    v_perm_b32 v43, v38, v34, s27
    global_store_dwordx4 v5, v[40:43], s[24:25] offset:16
    s_nop 1
    v_perm_b32 v40, v15, v11, s26
    v_perm_b32 v41, v23, v19, s26
    v_perm_b32 v42, v31, v27, s26
    v_perm_b32 v43, v39, v35, s26
    global_store_dwordx4 v5, v[40:43], s[24:25] offset:32
    s_nop 1
    v_perm_b32 v40, v15, v11, s27
    v_perm_b32 v41, v23, v19, s27
    v_perm_b32 v42, v31, v27, s27
    v_perm_b32 v43, v39, v35, s27
    global_store_dwordx4 v5, v[40:43], s[24:25] offset:48
    s_nop 1
    s_branch L_k1_end
L_k1_wo:
    v_cmp_gt_u32 vcc, 160, v0
    s_and_saveexec_b64 s[30:31], vcc
    s_cbranch_execz L_k1_end
    v_cmp_le_u32 vcc, 80, v0
    s_nop 1
    v_cndmask_b32 v3, 0, 1, vcc
    v_mul_u32_u24 v4, 80, v3
    v_sub_u32 v1, v0, v4
    s_mul_i32 s21, s20, 20480
    s_add_u32 s22, s8, s21
    s_addc_u32 s23, s9, 0
    v_mul_u32_u24 v4, 10240, v3
    v_lshlrev_b32 v2, 4, v1
    v_add_u32 v2, v2, v4
    global_load_dwordx4 v[8:11], v2, s[22:23]
    s_add_u32 s22, s22, 1280
    s_addc_u32 s23, s23, 0
    global_load_dwordx4 v[12:15], v2, s[22:23]
    s_add_u32 s22, s22, 1280
    s_addc_u32 s23, s23, 0
    global_load_dwordx4 v[16:19], v2, s[22:23]
    s_add_u32 s22, s22, 1280
    s_addc_u32 s23, s23, 0
    global_load_dwordx4 v[20:23], v2, s[22:23]
    s_add_u32 s22, s22, 1280
    s_addc_u32 s23, s23, 0
    global_load_dwordx4 v[24:27], v2, s[22:23]
    s_add_u32 s22, s22, 1280
    s_addc_u32 s23, s23, 0
    global_load_dwordx4 v[28:31], v2, s[22:23]
    s_add_u32 s22, s22, 1280
    s_addc_u32 s23, s23, 0
    global_load_dwordx4 v[32:35], v2, s[22:23]
    s_add_u32 s22, s22, 1280
    s_addc_u32 s23, s23, 0
    global_load_dwordx4 v[36:39], v2, s[22:23]
    s_lshl_b32 s21, s20, 1
    s_add_u32 s21, s21, 0
    v_add_u32 v6, s21, v3
    v_lshrrev_b32 v4, 1, v1
    v_mul_u32_u24 v4, 75776, v4
    v_lshrrev_b32 v5, 2, v6
    v_lshlrev_b32 v5, 10, v5
    v_add_u32 v4, v4, v5
    v_and_b32 v5, 3, v6
    v_lshlrev_b32 v5, 8, v5
    v_add_u32 v4, v4, v5
    v_and_b32 v5, 1, v1
    v_lshlrev_b32 v5, 7, v5
    v_add_u32 v4, v4, v5
    s_add_u32 s24, s18, 0xc00000
    s_addc_u32 s25, s19, 0
    s_mov_b32 s26, 0x05040100
    s_mov_b32 s27, 0x07060302
    s_waitcnt vmcnt(0)
    v_perm_b32 v40, v12, v8, s26
    v_perm_b32 v41, v20, v16, s26
    v_perm_b32 v42, v28, v24, s26
    v_perm_b32 v43, v36, v32, s26
    global_store_dwordx4 v4, v[40:43], s[24:25] offset:0
    s_nop 1
    v_perm_b32 v40, v12, v8, s27
    v_perm_b32 v41, v20, v16, s27
    v_perm_b32 v42, v28, v24, s27
    v_perm_b32 v43, v36, v32, s27
    global_store_dwordx4 v4, v[40:43], s[24:25] offset:16
    s_nop 1
    v_perm_b32 v40, v13, v9, s26
    v_perm_b32 v41, v21, v17, s26
    v_perm_b32 v42, v29, v25, s26
    v_perm_b32 v43, v37, v33, s26
    global_store_dwordx4 v4, v[40:43], s[24:25] offset:32
    s_nop 1
    v_perm_b32 v40, v13, v9, s27
    v_perm_b32 v41, v21, v17, s27
    v_perm_b32 v42, v29, v25, s27
    v_perm_b32 v43, v37, v33, s27
    global_store_dwordx4 v4, v[40:43], s[24:25] offset:48
    s_nop 1
    v_perm_b32 v40, v14, v10, s26
    v_perm_b32 v41, v22, v18, s26
    v_perm_b32 v42, v30, v26, s26
    v_perm_b32 v43, v38, v34, s26
    global_store_dwordx4 v4, v[40:43], s[24:25] offset:64
    s_nop 1
    v_perm_b32 v40, v14, v10, s27
    v_perm_b32 v41, v22, v18, s27
    v_perm_b32 v42, v30, v26, s27
    v_perm_b32 v43, v38, v34, s27
    global_store_dwordx4 v4, v[40:43], s[24:25] offset:80
    s_nop 1
    v_perm_b32 v40, v15, v11, s26
    v_perm_b32 v41, v23, v19, s26
    v_perm_b32 v42, v31, v27, s26
    v_perm_b32 v43, v39, v35, s26
    global_store_dwordx4 v4, v[40:43], s[24:25] offset:96
    s_nop 1
    v_perm_b32 v40, v15, v11, s27
    v_perm_b32 v41, v23, v19, s27
    v_perm_b32 v42, v31, v27, s27
    v_perm_b32 v43, v39, v35, s27
    global_store_dwordx4 v4, v[40:43], s[24:25] offset:112
    s_nop 1
    s_branch L_k1_end
L_k1_wd:
    v_cmp_gt_u32 vcc, 160, v0
    s_and_saveexec_b64 s[30:31], vcc
    s_cbranch_execz L_k1_end
    v_cmp_le_u32 vcc, 80, v0
    s_nop 1
    v_cndmask_b32 v3, 0, 1, vcc
    v_mul_u32_u24 v4, 80, v3
    v_sub_u32 v1, v0, v4
    s_mul_i32 s21, s20, 20480
    s_add_u32 s22, s16, s21
    s_addc_u32 s23, s17, 0
    v_mul_u32_u24 v4, 10240, v3
    v_lshlrev_b32 v2, 4, v1
    v_add_u32 v2, v2, v4
    global_load_dwordx4 v[8:11], v2, s[22:23]
    s_add_u32 s22, s22, 1280
    s_addc_u32 s23, s23, 0
    global_load_dwordx4 v[12:15], v2, s[22:23]
    s_add_u32 s22, s22, 1280
    s_addc_u32 s23, s23, 0
    global_load_dwordx4 v[16:19], v2, s[22:23]
    s_add_u32 s22, s22, 1280
    s_addc_u32 s23, s23, 0
    global_load_dwordx4 v[20:23], v2, s[22:23]
    s_add_u32 s22, s22, 1280
    s_addc_u32 s23, s23, 0
    global_load_dwordx4 v[24:27], v2, s[22:23]
    s_add_u32 s22, s22, 1280
    s_addc_u32 s23, s23, 0
    global_load_dwordx4 v[28:31], v2, s[22:23]
    s_add_u32 s22, s22, 1280
    s_addc_u32 s23, s23, 0
    global_load_dwordx4 v[32:35], v2, s[22:23]
    s_add_u32 s22, s22, 1280
    s_addc_u32 s23, s23, 0
    global_load_dwordx4 v[36:39], v2, s[22:23]
    s_lshl_b32 s21, s20, 1
    s_add_u32 s21, s21, 80
    v_add_u32 v6, s21, v3
    v_lshrrev_b32 v4, 1, v1
    v_mul_u32_u24 v4, 75776, v4
    v_lshrrev_b32 v5, 2, v6
    v_lshlrev_b32 v5, 10, v5
    v_add_u32 v4, v4, v5
    v_and_b32 v5, 3, v6
    v_lshlrev_b32 v5, 8, v5
    v_add_u32 v4, v4, v5
    v_and_b32 v5, 1, v1
    v_lshlrev_b32 v5, 7, v5
    v_add_u32 v4, v4, v5
    s_add_u32 s24, s18, 0xc00000
    s_addc_u32 s25, s19, 0
    s_mov_b32 s26, 0x05040100
    s_mov_b32 s27, 0x07060302
    s_waitcnt vmcnt(0)
    v_perm_b32 v40, v12, v8, s26
    v_perm_b32 v41, v20, v16, s26
    v_perm_b32 v42, v28, v24, s26
    v_perm_b32 v43, v36, v32, s26
    global_store_dwordx4 v4, v[40:43], s[24:25] offset:0
    s_nop 1
    v_perm_b32 v40, v12, v8, s27
    v_perm_b32 v41, v20, v16, s27
    v_perm_b32 v42, v28, v24, s27
    v_perm_b32 v43, v36, v32, s27
    global_store_dwordx4 v4, v[40:43], s[24:25] offset:16
    s_nop 1
    v_perm_b32 v40, v13, v9, s26
    v_perm_b32 v41, v21, v17, s26
    v_perm_b32 v42, v29, v25, s26
    v_perm_b32 v43, v37, v33, s26
    global_store_dwordx4 v4, v[40:43], s[24:25] offset:32
    s_nop 1
    v_perm_b32 v40, v13, v9, s27
    v_perm_b32 v41, v21, v17, s27
    v_perm_b32 v42, v29, v25, s27
    v_perm_b32 v43, v37, v33, s27
    global_store_dwordx4 v4, v[40:43], s[24:25] offset:48
    s_nop 1
    v_perm_b32 v40, v14, v10, s26
    v_perm_b32 v41, v22, v18, s26
    v_perm_b32 v42, v30, v26, s26
    v_perm_b32 v43, v38, v34, s26
    global_store_dwordx4 v4, v[40:43], s[24:25] offset:64
    s_nop 1
    v_perm_b32 v40, v14, v10, s27
    v_perm_b32 v41, v22, v18, s27
    v_perm_b32 v42, v30, v26, s27
    v_perm_b32 v43, v38, v34, s27
    global_store_dwordx4 v4, v[40:43], s[24:25] offset:80
    s_nop 1
    v_perm_b32 v40, v15, v11, s26
    v_perm_b32 v41, v23, v19, s26
    v_perm_b32 v42, v31, v27, s26
    v_perm_b32 v43, v39, v35, s26
    global_store_dwordx4 v4, v[40:43], s[24:25] offset:96
    s_nop 1
    v_perm_b32 v40, v15, v11, s27
    v_perm_b32 v41, v23, v19, s27
    v_perm_b32 v42, v31, v27, s27
    v_perm_b32 v43, v39, v35, s27
    global_store_dwordx4 v4, v[40:43], s[24:25] offset:112
    s_nop 1
    s_branch L_k1_end
L_k1_ln:
    v_and_b32 v1, 63, v0
    v_lshrrev_b32 v2, 6, v0
    v_and_b32 v3, 15, v1
    v_lshrrev_b32 v4, 4, v1
    v_mul_u32_u24 v5, 1280, v3
    v_mul_u32_u24 v6, 320, v2
    v_add_u32 v5, v5, v6
    v_lshlrev_b32 v6, 4, v4
    v_add_u32 v5, v5, v6
    s_mul_i32 s20, s2, 20480
    s_add_u32 s22, s4, s20
    s_addc_u32 s23, s5, 0
    global_load_dwordx4 v[8:11], v5, s[22:23] offset:0
    global_load_dwordx4 v[12:15], v5, s[22:23] offset:64
    global_load_dwordx4 v[16:19], v5, s[22:23] offset:128
    global_load_dwordx4 v[20:23], v5, s[22:23] offset:192
    global_load_dwordx4 v[24:27], v5, s[22:23] offset:256
    s_waitcnt vmcnt(0)
    v_lshlrev_b32 v28, 16, v8
    v_and_b32 v29, 0xffff0000, v8
    v_lshlrev_b32 v30, 16, v9
    v_and_b32 v31, 0xffff0000, v9
    v_lshlrev_b32 v32, 16, v10
    v_and_b32 v33, 0xffff0000, v10
    v_lshlrev_b32 v34, 16, v11
    v_and_b32 v35, 0xffff0000, v11
    v_lshlrev_b32 v36, 16, v12
    v_and_b32 v37, 0xffff0000, v12
    v_lshlrev_b32 v38, 16, v13
    v_and_b32 v39, 0xffff0000, v13
    v_lshlrev_b32 v40, 16, v14
    v_and_b32 v41, 0xffff0000, v14
    v_lshlrev_b32 v42, 16, v15
    v_and_b32 v43, 0xffff0000, v15
    v_lshlrev_b32 v44, 16, v16
    v_and_b32 v45, 0xffff0000, v16
    v_lshlrev_b32 v46, 16, v17
    v_and_b32 v47, 0xffff0000, v17
    v_lshlrev_b32 v48, 16, v18
    v_and_b32 v49, 0xffff0000, v18
    v_lshlrev_b32 v50, 16, v19
    v_and_b32 v51, 0xffff0000, v19
    v_lshlrev_b32 v52, 16, v20
    v_and_b32 v53, 0xffff0000, v20
    v_lshlrev_b32 v54, 16, v21
    v_and_b32 v55, 0xffff0000, v21
    v_lshlrev_b32 v56, 16, v22
    v_and_b32 v57, 0xffff0000, v22
    v_lshlrev_b32 v58, 16, v23
    v_and_b32 v59, 0xffff0000, v23
    v_lshlrev_b32 v60, 16, v24
    v_and_b32 v61, 0xffff0000, v24
    v_lshlrev_b32 v62, 16, v25
    v_and_b32 v63, 0xffff0000, v25
    v_lshlrev_b32 v64, 16, v26
    v_and_b32 v65, 0xffff0000, v26
    v_lshlrev_b32 v66, 16, v27
    v_and_b32 v67, 0xffff0000, v27
    v_add_f32 v68, v28, v29
    v_add_f32 v68, v68, v30
    v_add_f32 v68, v68, v31
    v_add_f32 v68, v68, v32
    v_add_f32 v68, v68, v33
    v_add_f32 v68, v68, v34
    v_add_f32 v68, v68, v35
    v_add_f32 v68, v68, v36
    v_add_f32 v68, v68, v37
    v_add_f32 v68, v68, v38
    v_add_f32 v68, v68, v39
    v_add_f32 v68, v68, v40
    v_add_f32 v68, v68, v41
    v_add_f32 v68, v68, v42
    v_add_f32 v68, v68, v43
    v_add_f32 v68, v68, v44
    v_add_f32 v68, v68, v45
    v_add_f32 v68, v68, v46
    v_add_f32 v68, v68, v47
    v_add_f32 v68, v68, v48
    v_add_f32 v68, v68, v49
    v_add_f32 v68, v68, v50
    v_add_f32 v68, v68, v51
    v_add_f32 v68, v68, v52
    v_add_f32 v68, v68, v53
    v_add_f32 v68, v68, v54
    v_add_f32 v68, v68, v55
    v_add_f32 v68, v68, v56
    v_add_f32 v68, v68, v57
    v_add_f32 v68, v68, v58
    v_add_f32 v68, v68, v59
    v_add_f32 v68, v68, v60
    v_add_f32 v68, v68, v61
    v_add_f32 v68, v68, v62
    v_add_f32 v68, v68, v63
    v_add_f32 v68, v68, v64
    v_add_f32 v68, v68, v65
    v_add_f32 v68, v68, v66
    v_add_f32 v68, v68, v67
    v_lshlrev_b32 v6, 6, v3
    v_lshlrev_b32 v7, 4, v2
    v_add_u32 v6, v6, v7
    v_lshlrev_b32 v7, 2, v4
    v_add_u32 v6, v6, v7
    v_lshlrev_b32 v7, 6, v3
    ds_write_b32 v6, v68
    s_waitcnt lgkmcnt(0)
    s_barrier
    ds_read_b128 v[72:75], v7 offset:0
    ds_read_b128 v[76:79], v7 offset:16
    ds_read_b128 v[80:83], v7 offset:32
    ds_read_b128 v[84:87], v7 offset:48
    s_waitcnt lgkmcnt(0)
    v_add_f32 v68, v72, v73
    v_add_f32 v68, v68, v74
    v_add_f32 v68, v68, v75
    v_add_f32 v68, v68, v76
    v_add_f32 v68, v68, v77
    v_add_f32 v68, v68, v78
    v_add_f32 v68, v68, v79
    v_add_f32 v68, v68, v80
    v_add_f32 v68, v68, v81
    v_add_f32 v68, v68, v82
    v_add_f32 v68, v68, v83
    v_add_f32 v68, v68, v84
    v_add_f32 v68, v68, v85
    v_add_f32 v68, v68, v86
    v_add_f32 v68, v68, v87
    v_mul_f32 v69, 0x3acccccd, v68
    v_sub_f32 v28, v28, v69
    v_sub_f32 v29, v29, v69
    v_sub_f32 v30, v30, v69
    v_sub_f32 v31, v31, v69
    v_sub_f32 v32, v32, v69
    v_sub_f32 v33, v33, v69
    v_sub_f32 v34, v34, v69
    v_sub_f32 v35, v35, v69
    v_sub_f32 v36, v36, v69
    v_sub_f32 v37, v37, v69
    v_sub_f32 v38, v38, v69
    v_sub_f32 v39, v39, v69
    v_sub_f32 v40, v40, v69
    v_sub_f32 v41, v41, v69
    v_sub_f32 v42, v42, v69
    v_sub_f32 v43, v43, v69
    v_sub_f32 v44, v44, v69
    v_sub_f32 v45, v45, v69
    v_sub_f32 v46, v46, v69
    v_sub_f32 v47, v47, v69
    v_sub_f32 v48, v48, v69
    v_sub_f32 v49, v49, v69
    v_sub_f32 v50, v50, v69
    v_sub_f32 v51, v51, v69
    v_sub_f32 v52, v52, v69
    v_sub_f32 v53, v53, v69
    v_sub_f32 v54, v54, v69
    v_sub_f32 v55, v55, v69
    v_sub_f32 v56, v56, v69
    v_sub_f32 v57, v57, v69
    v_sub_f32 v58, v58, v69
    v_sub_f32 v59, v59, v69
    v_sub_f32 v60, v60, v69
    v_sub_f32 v61, v61, v69
    v_sub_f32 v62, v62, v69
    v_sub_f32 v63, v63, v69
    v_sub_f32 v64, v64, v69
    v_sub_f32 v65, v65, v69
    v_sub_f32 v66, v66, v69
    v_sub_f32 v67, v67, v69
    v_mul_f32 v68, v28, v28
    v_fmac_f32 v68, v29, v29
    v_fmac_f32 v68, v30, v30
    v_fmac_f32 v68, v31, v31
    v_fmac_f32 v68, v32, v32
    v_fmac_f32 v68, v33, v33
    v_fmac_f32 v68, v34, v34
    v_fmac_f32 v68, v35, v35
    v_fmac_f32 v68, v36, v36
    v_fmac_f32 v68, v37, v37
    v_fmac_f32 v68, v38, v38
    v_fmac_f32 v68, v39, v39
    v_fmac_f32 v68, v40, v40
    v_fmac_f32 v68, v41, v41
    v_fmac_f32 v68, v42, v42
    v_fmac_f32 v68, v43, v43
    v_fmac_f32 v68, v44, v44
    v_fmac_f32 v68, v45, v45
    v_fmac_f32 v68, v46, v46
    v_fmac_f32 v68, v47, v47
    v_fmac_f32 v68, v48, v48
    v_fmac_f32 v68, v49, v49
    v_fmac_f32 v68, v50, v50
    v_fmac_f32 v68, v51, v51
    v_fmac_f32 v68, v52, v52
    v_fmac_f32 v68, v53, v53
    v_fmac_f32 v68, v54, v54
    v_fmac_f32 v68, v55, v55
    v_fmac_f32 v68, v56, v56
    v_fmac_f32 v68, v57, v57
    v_fmac_f32 v68, v58, v58
    v_fmac_f32 v68, v59, v59
    v_fmac_f32 v68, v60, v60
    v_fmac_f32 v68, v61, v61
    v_fmac_f32 v68, v62, v62
    v_fmac_f32 v68, v63, v63
    v_fmac_f32 v68, v64, v64
    v_fmac_f32 v68, v65, v65
    v_fmac_f32 v68, v66, v66
    v_fmac_f32 v68, v67, v67
    ds_write_b32 v6, v68 offset:1024
    s_waitcnt lgkmcnt(0)
    s_barrier
    ds_read_b128 v[72:75], v7 offset:1024
    ds_read_b128 v[76:79], v7 offset:1040
    ds_read_b128 v[80:83], v7 offset:1056
    ds_read_b128 v[84:87], v7 offset:1072
    s_waitcnt lgkmcnt(0)
    v_add_f32 v68, v72, v73
    v_add_f32 v68, v68, v74
    v_add_f32 v68, v68, v75
    v_add_f32 v68, v68, v76
    v_add_f32 v68, v68, v77
    v_add_f32 v68, v68, v78
    v_add_f32 v68, v68, v79
    v_add_f32 v68, v68, v80
    v_add_f32 v68, v68, v81
    v_add_f32 v68, v68, v82
    v_add_f32 v68, v68, v83
    v_add_f32 v68, v68, v84
    v_add_f32 v68, v68, v85
    v_add_f32 v68, v68, v86
    v_add_f32 v68, v68, v87
    v_mov_b32 v70, 0x3727c5ac
    v_fmac_f32 v70, 0x3acccccd, v68
    v_rsq_f32 v70, v70
    s_nop 1
    v_mul_f32 v28, v28, v70
    v_mul_f32 v29, v29, v70
    v_mul_f32 v30, v30, v70
    v_mul_f32 v31, v31, v70
    v_mul_f32 v32, v32, v70
    v_mul_f32 v33, v33, v70
    v_mul_f32 v34, v34, v70
    v_mul_f32 v35, v35, v70
    v_mul_f32 v36, v36, v70
    v_mul_f32 v37, v37, v70
    v_mul_f32 v38, v38, v70
    v_mul_f32 v39, v39, v70
    v_mul_f32 v40, v40, v70
    v_mul_f32 v41, v41, v70
    v_mul_f32 v42, v42, v70
    v_mul_f32 v43, v43, v70
    v_mul_f32 v44, v44, v70
    v_mul_f32 v45, v45, v70
    v_mul_f32 v46, v46, v70
    v_mul_f32 v47, v47, v70
    v_mul_f32 v48, v48, v70
    v_mul_f32 v49, v49, v70
    v_mul_f32 v50, v50, v70
    v_mul_f32 v51, v51, v70
    v_mul_f32 v52, v52, v70
    v_mul_f32 v53, v53, v70
    v_mul_f32 v54, v54, v70
    v_mul_f32 v55, v55, v70
    v_mul_f32 v56, v56, v70
    v_mul_f32 v57, v57, v70
    v_mul_f32 v58, v58, v70
    v_mul_f32 v59, v59, v70
    v_mul_f32 v60, v60, v70
    v_mul_f32 v61, v61, v70
    v_mul_f32 v62, v62, v70
    v_mul_f32 v63, v63, v70
    v_mul_f32 v64, v64, v70
    v_mul_f32 v65, v65, v70
    v_mul_f32 v66, v66, v70
    v_mul_f32 v67, v67, v70
    v_cvt_pk_bf16_f32 v8, v28, v29
    v_cvt_pk_bf16_f32 v9, v30, v31
    v_cvt_pk_bf16_f32 v10, v32, v33
    v_cvt_pk_bf16_f32 v11, v34, v35
    v_cvt_pk_bf16_f32 v12, v36, v37
    v_cvt_pk_bf16_f32 v13, v38, v39
    v_cvt_pk_bf16_f32 v14, v40, v41
    v_cvt_pk_bf16_f32 v15, v42, v43
    v_cvt_pk_bf16_f32 v16, v44, v45
    v_cvt_pk_bf16_f32 v17, v46, v47
    v_cvt_pk_bf16_f32 v18, v48, v49
    v_cvt_pk_bf16_f32 v19, v50, v51
    v_cvt_pk_bf16_f32 v20, v52, v53
    v_cvt_pk_bf16_f32 v21, v54, v55
    v_cvt_pk_bf16_f32 v22, v56, v57
    v_cvt_pk_bf16_f32 v23, v58, v59
    v_cvt_pk_bf16_f32 v24, v60, v61
    v_cvt_pk_bf16_f32 v25, v62, v63
    v_cvt_pk_bf16_f32 v26, v64, v65
    v_cvt_pk_bf16_f32 v27, v66, v67
    v_mul_u32_u24 v5, 5120, v2
    v_lshlrev_b32 v6, 4, v1
    v_add_u32 v5, v5, v6
    s_mul_i32 s20, s2, 20480
    s_add_u32 s22, s18, 0x0
    s_addc_u32 s23, s19, 0
    s_add_u32 s22, s22, s20
    s_addc_u32 s23, s23, 0
    global_store_dwordx4 v5, v[8:11], s[22:23] offset:0
    global_store_dwordx4 v5, v[12:15], s[22:23] offset:1024
    global_store_dwordx4 v5, v[16:19], s[22:23] offset:2048
    global_store_dwordx4 v5, v[20:23], s[22:23] offset:3072
    v_add_u32 v5, 4096, v5
    global_store_dwordx4 v5, v[24:27], s[22:23]
L_k1_end:
    s_endpgm
.p2align 8
.globl k2_gemm1_kernel
.type k2_gemm1_kernel,@function
k2_gemm1_kernel:
    s_cmp_ge_u32 s2, 224
    s_cbranch_scc1 L_k2_end
    s_load_dwordx2 s[18:19], s[0:1], 72
    s_and_b32 s4, s2, 1
    s_lshl_b32 s4, s4, 2
    s_bfe_u32 s5, s2, 0x20003
    s_add_u32 s4, s4, s5
    s_bfe_u32 s5, s2, 0x20001
    s_mul_i32 s5, s5, 7
    s_lshr_b32 s7, s2, 5
    s_add_u32 s5, s5, s7
    v_lshrrev_b32 v1, 6, v0
    v_and_b32 v2, 63, v0
    s_nop 0
    v_readfirstlane_b32 s6, v1
    v_lshlrev_b32 v3, 4, v2
    s_mul_i32 s8, s6, 43
    s_lshr_b32 s8, s8, 7
    s_mul_i32 s7, s8, 3
    s_sub_u32 s7, s6, s7
    s_mul_i32 s10, s5, 245760
    s_add_u32 s10, s10, 0x400000
    s_mul_i32 s11, s4, 327680
    s_add_u32 s11, s11, 0x0
    s_add_u32 s12, s6, 0
    s_lshl_b32 s24, s12, 10
    s_cmp_lt_u32 s12, 12
    s_cselect_b32 s13, 0, 12
    s_sub_u32 s13, s12, s13
    s_mul_i32 s14, s13, 20480
    s_cmp_lt_u32 s12, 12
    s_cselect_b32 s13, s10, s11
    s_add_u32 s14, s14, s13
    v_add_u32 v4, s14, v3
    s_add_u32 s12, s6, 12
    s_lshl_b32 s25, s12, 10
    s_cmp_lt_u32 s12, 12
    s_cselect_b32 s13, 0, 12
    s_sub_u32 s13, s12, s13
    s_mul_i32 s14, s13, 20480
    s_cmp_lt_u32 s12, 12
    s_cselect_b32 s13, s10, s11
    s_add_u32 s14, s14, s13
    v_add_u32 v5, s14, v3
    s_add_u32 s12, s6, 24
    s_lshl_b32 s26, s12, 10
    s_cmp_lt_u32 s12, 12
    s_cselect_b32 s13, 0, 12
    s_sub_u32 s13, s12, s13
    s_mul_i32 s14, s13, 20480
    s_cmp_lt_u32 s12, 12
    s_cselect_b32 s13, s10, s11
    s_add_u32 s14, s14, s13
    v_add_u32 v6, s14, v3
    s_waitcnt lgkmcnt(0)
    s_mov_b32 s12, s18
    s_mov_b32 s13, s19
    s_lshl_b32 s15, s7, 12
    v_add_u32 v9, s15, v3
    s_lshl_b32 s15, s8, 12
    s_add_u32 s15, s15, 12288
    v_add_u32 v10, s15, v3
    v_add_u32 v11, 57344, v9
    v_add_u32 v12, 57344, v10
    v_add_u32 v13, 114688, v9
    v_add_u32 v14, 114688, v10
    s_add_u32 m0, s24, 0
    s_nop 0
    global_load_lds_dwordx4 v4, s[12:13]
    s_add_u32 m0, s25, 0
    s_nop 0
    global_load_lds_dwordx4 v5, s[12:13]
    s_cmp_ge_u32 s6, 4
    s_cbranch_scc1 L_k2_d1
    s_add_u32 m0, s26, 0
    s_nop 0
    global_load_lds_dwordx4 v6, s[12:13]
L_k2_d1:
    s_add_u32 s12, s12, 1024
    s_addc_u32 s13, s13, 0
    s_add_u32 m0, s24, 28672
    s_nop 0
    global_load_lds_dwordx4 v4, s[12:13]
    s_add_u32 m0, s25, 28672
    s_nop 0
    global_load_lds_dwordx4 v5, s[12:13]
    s_cmp_ge_u32 s6, 4
    s_cbranch_scc1 L_k2_d2
    s_add_u32 m0, s26, 28672
    s_nop 0
    global_load_lds_dwordx4 v6, s[12:13]
L_k2_d2:
    s_add_u32 s12, s12, 1024
    s_addc_u32 s13, s13, 0
    s_add_u32 m0, s24, 57344
    s_nop 0
    global_load_lds_dwordx4 v4, s[12:13]
    s_add_u32 m0, s25, 57344
    s_nop 0
    global_load_lds_dwordx4 v5, s[12:13]
    s_cmp_ge_u32 s6, 4
    s_cbranch_scc1 L_k2_d3
    s_add_u32 m0, s26, 57344
    s_nop 0
    global_load_lds_dwordx4 v6, s[12:13]
L_k2_d3:
    s_add_u32 s12, s12, 1024
    s_addc_u32 s13, s13, 0
    s_add_u32 m0, s24, 86016
    s_nop 0
    global_load_lds_dwordx4 v4, s[12:13]
    s_add_u32 m0, s25, 86016
    s_nop 0
    global_load_lds_dwordx4 v5, s[12:13]
    s_cmp_ge_u32 s6, 4
    s_cbranch_scc1 L_k2_d4
    s_add_u32 m0, s26, 86016
    s_nop 0
    global_load_lds_dwordx4 v6, s[12:13]
L_k2_d4:
    s_add_u32 s12, s12, 1024
    s_addc_u32 s13, s13, 0
    s_cmp_ge_u32 s6, 4
    s_cbranch_scc1 L_k2_w5
    s_waitcnt vmcnt(9)
    s_branch L_k2_x5
L_k2_w5:
    s_waitcnt vmcnt(6)
L_k2_x5:
    s_barrier
    ds_read_b128 v[80:83], v9 offset:0
    ds_read_b128 v[96:99], v10 offset:0
    ds_read_b128 v[84:87], v9 offset:1024
    ds_read_b128 v[100:103], v10 offset:1024
    ds_read_b128 v[88:91], v9 offset:2048
    ds_read_b128 v[104:107], v10 offset:2048
    ds_read_b128 v[92:95], v9 offset:3072
    ds_read_b128 v[108:111], v10 offset:3072
    s_cmp_ge_u32 s6, 4
    s_cbranch_scc1 L_k2_w6
    s_waitcnt vmcnt(6)
    s_branch L_k2_x6
L_k2_w6:
    s_waitcnt vmcnt(4)
L_k2_x6:
    s_barrier
    s_add_u32 m0, s24, 114688
    s_nop 0
    global_load_lds_dwordx4 v4, s[12:13]
    s_add_u32 m0, s25, 114688
    s_nop 0
    global_load_lds_dwordx4 v5, s[12:13]
    s_cmp_ge_u32 s6, 4
    s_cbranch_scc1 L_k2_d7
    s_add_u32 m0, s26, 114688
    s_nop 0
    global_load_lds_dwordx4 v6, s[12:13]
L_k2_d7:
    s_add_u32 s12, s12, 1024
    s_addc_u32 s13, s13, 0
    ds_read_b128 v[112:115], v9 offset:28672
    ds_read_b128 v[128:131], v10 offset:28672
    ds_read_b128 v[116:119], v9 offset:29696
    ds_read_b128 v[132:135], v10 offset:29696
    ds_read_b128 v[120:123], v9 offset:30720
    ds_read_b128 v[136:139], v10 offset:30720
    ds_read_b128 v[124:127], v9 offset:31744
    ds_read_b128 v[140:143], v10 offset:31744
    s_waitcnt lgkmcnt(8)
    v_mfma_f32_16x16x32_bf16 v[16:19], v[80:83], v[96:99], 0
    v_mfma_f32_16x16x32_bf16 v[20:23], v[80:83], v[100:103], 0
    v_mfma_f32_16x16x32_bf16 v[24:27], v[80:83], v[104:107], 0
    v_mfma_f32_16x16x32_bf16 v[28:31], v[80:83], v[108:111], 0
    v_mfma_f32_16x16x32_bf16 v[32:35], v[84:87], v[96:99], 0
    v_mfma_f32_16x16x32_bf16 v[36:39], v[84:87], v[100:103], 0
    v_mfma_f32_16x16x32_bf16 v[40:43], v[84:87], v[104:107], 0
    v_mfma_f32_16x16x32_bf16 v[44:47], v[84:87], v[108:111], 0
    v_mfma_f32_16x16x32_bf16 v[48:51], v[88:91], v[96:99], 0
    v_mfma_f32_16x16x32_bf16 v[52:55], v[88:91], v[100:103], 0
    v_mfma_f32_16x16x32_bf16 v[56:59], v[88:91], v[104:107], 0
    v_mfma_f32_16x16x32_bf16 v[60:63], v[88:91], v[108:111], 0
    v_mfma_f32_16x16x32_bf16 v[64:67], v[92:95], v[96:99], 0
    v_mfma_f32_16x16x32_bf16 v[68:71], v[92:95], v[100:103], 0
    v_mfma_f32_16x16x32_bf16 v[72:75], v[92:95], v[104:107], 0
    v_mfma_f32_16x16x32_bf16 v[76:79], v[92:95], v[108:111], 0
    s_cmp_ge_u32 s6, 4
    s_cbranch_scc1 L_k2_w8
    s_waitcnt vmcnt(6)
    s_branch L_k2_x8
L_k2_w8:
    s_waitcnt vmcnt(4)
L_k2_x8:
    s_barrier
    s_add_u32 m0, s24, 0
    s_nop 0
    global_load_lds_dwordx4 v4, s[12:13]
    s_add_u32 m0, s25, 0
    s_nop 0
    global_load_lds_dwordx4 v5, s[12:13]
    s_cmp_ge_u32 s6, 4
    s_cbranch_scc1 L_k2_d9
    s_add_u32 m0, s26, 0
    s_nop 0
    global_load_lds_dwordx4 v6, s[12:13]
L_k2_d9:
    s_add_u32 s12, s12, 1024
    s_addc_u32 s13, s13, 0
    ds_read_b128 v[80:83], v11 offset:0
    ds_read_b128 v[96:99], v12 offset:0
    ds_read_b128 v[84:87], v11 offset:1024
    ds_read_b128 v[100:103], v12 offset:1024
    ds_read_b128 v[88:91], v11 offset:2048
    ds_read_b128 v[104:107], v12 offset:2048
    ds_read_b128 v[92:95], v11 offset:3072
    ds_read_b128 v[108:111], v12 offset:3072
    s_waitcnt lgkmcnt(8)
    v_mfma_f32_16x16x32_bf16 v[16:19], v[112:115], v[128:131], v[16:19]
    v_mfma_f32_16x16x32_bf16 v[20:23], v[112:115], v[132:135], v[20:23]
    v_mfma_f32_16x16x32_bf16 v[24:27], v[112:115], v[136:139], v[24:27]
    v_mfma_f32_16x16x32_bf16 v[28:31], v[112:115], v[140:143], v[28:31]
    v_mfma_f32_16x16x32_bf16 v[32:35], v[116:119], v[128:131], v[32:35]
    v_mfma_f32_16x16x32_bf16 v[36:39], v[116:119], v[132:135], v[36:39]
    v_mfma_f32_16x16x32_bf16 v[40:43], v[116:119], v[136:139], v[40:43]
    v_mfma_f32_16x16x32_bf16 v[44:47], v[116:119], v[140:143], v[44:47]
    v_mfma_f32_16x16x32_bf16 v[48:51], v[120:123], v[128:131], v[48:51]
    v_mfma_f32_16x16x32_bf16 v[52:55], v[120:123], v[132:135], v[52:55]
    v_mfma_f32_16x16x32_bf16 v[56:59], v[120:123], v[136:139], v[56:59]
    v_mfma_f32_16x16x32_bf16 v[60:63], v[120:123], v[140:143], v[60:63]
    v_mfma_f32_16x16x32_bf16 v[64:67], v[124:127], v[128:131], v[64:67]
    v_mfma_f32_16x16x32_bf16 v[68:71], v[124:127], v[132:135], v[68:71]
    v_mfma_f32_16x16x32_bf16 v[72:75], v[124:127], v[136:139], v[72:75]
    v_mfma_f32_16x16x32_bf16 v[76:79], v[124:127], v[140:143], v[76:79]
    s_cmp_ge_u32 s6, 4
    s_cbranch_scc1 L_k2_w10
    s_waitcnt vmcnt(6)
    s_branch L_k2_x10
L_k2_w10:
    s_waitcnt vmcnt(4)
L_k2_x10:
    s_barrier
    s_add_u32 m0, s24, 28672
    s_nop 0
    global_load_lds_dwordx4 v4, s[12:13]
    s_add_u32 m0, s25, 28672
    s_nop 0
    global_load_lds_dwordx4 v5, s[12:13]
    s_cmp_ge_u32 s6, 4
    s_cbranch_scc1 L_k2_d11
    s_add_u32 m0, s26, 28672
    s_nop 0
    global_load_lds_dwordx4 v6, s[12:13]
L_k2_d11:
    s_add_u32 s12, s12, 1024
    s_addc_u32 s13, s13, 0
    ds_read_b128 v[112:115], v11 offset:28672
    ds_read_b128 v[128:131], v12 offset:28672
    ds_read_b128 v[116:119], v11 offset:29696
    ds_read_b128 v[132:135], v12 offset:29696
    ds_read_b128 v[120:123], v11 offset:30720
    ds_read_b128 v[136:139], v12 offset:30720
    ds_read_b128 v[124:127], v11 offset:31744
    ds_read_b128 v[140:143], v12 offset:31744
    s_waitcnt lgkmcnt(8)
    v_mfma_f32_16x16x32_bf16 v[16:19], v[80:83], v[96:99], v[16:19]
    v_mfma_f32_16x16x32_bf16 v[20:23], v[80:83], v[100:103], v[20:23]
    v_mfma_f32_16x16x32_bf16 v[24:27], v[80:83], v[104:107], v[24:27]
    v_mfma_f32_16x16x32_bf16 v[28:31], v[80:83], v[108:111], v[28:31]
    v_mfma_f32_16x16x32_bf16 v[32:35], v[84:87], v[96:99], v[32:35]
    v_mfma_f32_16x16x32_bf16 v[36:39], v[84:87], v[100:103], v[36:39]
    v_mfma_f32_16x16x32_bf16 v[40:43], v[84:87], v[104:107], v[40:43]
    v_mfma_f32_16x16x32_bf16 v[44:47], v[84:87], v[108:111], v[44:47]
    v_mfma_f32_16x16x32_bf16 v[48:51], v[88:91], v[96:99], v[48:51]
    v_mfma_f32_16x16x32_bf16 v[52:55], v[88:91], v[100:103], v[52:55]
    v_mfma_f32_16x16x32_bf16 v[56:59], v[88:91], v[104:107], v[56:59]
    v_mfma_f32_16x16x32_bf16 v[60:63], v[88:91], v[108:111], v[60:63]
    v_mfma_f32_16x16x32_bf16 v[64:67], v[92:95], v[96:99], v[64:67]
    v_mfma_f32_16x16x32_bf16 v[68:71], v[92:95], v[100:103], v[68:71]
    v_mfma_f32_16x16x32_bf16 v[72:75], v[92:95], v[104:107], v[72:75]
    v_mfma_f32_16x16x32_bf16 v[76:79], v[92:95], v[108:111], v[76:79]
    s_cmp_ge_u32 s6, 4
    s_cbranch_scc1 L_k2_w12
    s_waitcnt vmcnt(6)
    s_branch L_k2_x12
L_k2_w12:
    s_waitcnt vmcnt(4)
L_k2_x12:
    s_barrier
    s_add_u32 m0, s24, 57344
    s_nop 0
    global_load_lds_dwordx4 v4, s[12:13]
    s_add_u32 m0, s25, 57344
    s_nop 0
    global_load_lds_dwordx4 v5, s[12:13]
    s_cmp_ge_u32 s6, 4
    s_cbranch_scc1 L_k2_d13
    s_add_u32 m0, s26, 57344
    s_nop 0
    global_load_lds_dwordx4 v6, s[12:13]
L_k2_d13:
    s_add_u32 s12, s12, 1024
    s_addc_u32 s13, s13, 0
    ds_read_b128 v[80:83], v13 offset:0
    ds_read_b128 v[96:99], v14 offset:0
    ds_read_b128 v[84:87], v13 offset:1024
    ds_read_b128 v[100:103], v14 offset:1024
    ds_read_b128 v[88:91], v13 offset:2048
    ds_read_b128 v[104:107], v14 offset:2048
    ds_read_b128 v[92:95], v13 offset:3072
    ds_read_b128 v[108:111], v14 offset:3072
    s_waitcnt lgkmcnt(8)
    v_mfma_f32_16x16x32_bf16 v[16:19], v[112:115], v[128:131], v[16:19]
    v_mfma_f32_16x16x32_bf16 v[20:23], v[112:115], v[132:135], v[20:23]
    v_mfma_f32_16x16x32_bf16 v[24:27], v[112:115], v[136:139], v[24:27]
    v_mfma_f32_16x16x32_bf16 v[28:31], v[112:115], v[140:143], v[28:31]
    v_mfma_f32_16x16x32_bf16 v[32:35], v[116:119], v[128:131], v[32:35]
    v_mfma_f32_16x16x32_bf16 v[36:39], v[116:119], v[132:135], v[36:39]
    v_mfma_f32_16x16x32_bf16 v[40:43], v[116:119], v[136:139], v[40:43]
    v_mfma_f32_16x16x32_bf16 v[44:47], v[116:119], v[140:143], v[44:47]
    v_mfma_f32_16x16x32_bf16 v[48:51], v[120:123], v[128:131], v[48:51]
    v_mfma_f32_16x16x32_bf16 v[52:55], v[120:123], v[132:135], v[52:55]
    v_mfma_f32_16x16x32_bf16 v[56:59], v[120:123], v[136:139], v[56:59]
    v_mfma_f32_16x16x32_bf16 v[60:63], v[120:123], v[140:143], v[60:63]
    v_mfma_f32_16x16x32_bf16 v[64:67], v[124:127], v[128:131], v[64:67]
    v_mfma_f32_16x16x32_bf16 v[68:71], v[124:127], v[132:135], v[68:71]
    v_mfma_f32_16x16x32_bf16 v[72:75], v[124:127], v[136:139], v[72:75]
    v_mfma_f32_16x16x32_bf16 v[76:79], v[124:127], v[140:143], v[76:79]
    s_cmp_ge_u32 s6, 4
    s_cbranch_scc1 L_k2_w14
    s_waitcnt vmcnt(6)
    s_branch L_k2_x14
L_k2_w14:
    s_waitcnt vmcnt(4)
L_k2_x14:
    s_barrier
    s_add_u32 m0, s24, 86016
    s_nop 0
    global_load_lds_dwordx4 v4, s[12:13]
    s_add_u32 m0, s25, 86016
    s_nop 0
    global_load_lds_dwordx4 v5, s[12:13]
    s_cmp_ge_u32 s6, 4
    s_cbranch_scc1 L_k2_d15
    s_add_u32 m0, s26, 86016
    s_nop 0
    global_load_lds_dwordx4 v6, s[12:13]
L_k2_d15:
    s_add_u32 s12, s12, 1024
    s_addc_u32 s13, s13, 0
    ds_read_b128 v[112:115], v9 offset:0
    ds_read_b128 v[128:131], v10 offset:0
    ds_read_b128 v[116:119], v9 offset:1024
    ds_read_b128 v[132:135], v10 offset:1024
    ds_read_b128 v[120:123], v9 offset:2048
    ds_read_b128 v[136:139], v10 offset:2048
    ds_read_b128 v[124:127], v9 offset:3072
    ds_read_b128 v[140:143], v10 offset:3072
    s_waitcnt lgkmcnt(8)
    v_mfma_f32_16x16x32_bf16 v[16:19], v[80:83], v[96:99], v[16:19]
    v_mfma_f32_16x16x32_bf16 v[20:23], v[80:83], v[100:103], v[20:23]
    v_mfma_f32_16x16x32_bf16 v[24:27], v[80:83], v[104:107], v[24:27]
    v_mfma_f32_16x16x32_bf16 v[28:31], v[80:83], v[108:111], v[28:31]
    v_mfma_f32_16x16x32_bf16 v[32:35], v[84:87], v[96:99], v[32:35]
    v_mfma_f32_16x16x32_bf16 v[36:39], v[84:87], v[100:103], v[36:39]
    v_mfma_f32_16x16x32_bf16 v[40:43], v[84:87], v[104:107], v[40:43]
    v_mfma_f32_16x16x32_bf16 v[44:47], v[84:87], v[108:111], v[44:47]
    v_mfma_f32_16x16x32_bf16 v[48:51], v[88:91], v[96:99], v[48:51]
    v_mfma_f32_16x16x32_bf16 v[52:55], v[88:91], v[100:103], v[52:55]
    v_mfma_f32_16x16x32_bf16 v[56:59], v[88:91], v[104:107], v[56:59]
    v_mfma_f32_16x16x32_bf16 v[60:63], v[88:91], v[108:111], v[60:63]
    v_mfma_f32_16x16x32_bf16 v[64:67], v[92:95], v[96:99], v[64:67]
    v_mfma_f32_16x16x32_bf16 v[68:71], v[92:95], v[100:103], v[68:71]
    v_mfma_f32_16x16x32_bf16 v[72:75], v[92:95], v[104:107], v[72:75]
    v_mfma_f32_16x16x32_bf16 v[76:79], v[92:95], v[108:111], v[76:79]
    s_cmp_ge_u32 s6, 4
    s_cbranch_scc1 L_k2_w16
    s_waitcnt vmcnt(6)
    s_branch L_k2_x16
L_k2_w16:
    s_waitcnt vmcnt(4)
L_k2_x16:
    s_barrier
    s_add_u32 m0, s24, 114688
    s_nop 0
    global_load_lds_dwordx4 v4, s[12:13]
    s_add_u32 m0, s25, 114688
    s_nop 0
    global_load_lds_dwordx4 v5, s[12:13]
    s_cmp_ge_u32 s6, 4
    s_cbranch_scc1 L_k2_d17
    s_add_u32 m0, s26, 114688
    s_nop 0
    global_load_lds_dwordx4 v6, s[12:13]
L_k2_d17:
    s_add_u32 s12, s12, 1024
    s_addc_u32 s13, s13, 0
    ds_read_b128 v[80:83], v9 offset:28672
    ds_read_b128 v[96:99], v10 offset:28672
    ds_read_b128 v[84:87], v9 offset:29696
    ds_read_b128 v[100:103], v10 offset:29696
    ds_read_b128 v[88:91], v9 offset:30720
    ds_read_b128 v[104:107], v10 offset:30720
    ds_read_b128 v[92:95], v9 offset:31744
    ds_read_b128 v[108:111], v10 offset:31744
    s_waitcnt lgkmcnt(8)
    v_mfma_f32_16x16x32_bf16 v[16:19], v[112:115], v[128:131], v[16:19]
    v_mfma_f32_16x16x32_bf16 v[20:23], v[112:115], v[132:135], v[20:23]
    v_mfma_f32_16x16x32_bf16 v[24:27], v[112:115], v[136:139], v[24:27]
    v_mfma_f32_16x16x32_bf16 v[28:31], v[112:115], v[140:143], v[28:31]
    v_mfma_f32_16x16x32_bf16 v[32:35], v[116:119], v[128:131], v[32:35]
    v_mfma_f32_16x16x32_bf16 v[36:39], v[116:119], v[132:135], v[36:39]
    v_mfma_f32_16x16x32_bf16 v[40:43], v[116:119], v[136:139], v[40:43]
    v_mfma_f32_16x16x32_bf16 v[44:47], v[116:119], v[140:143], v[44:47]
    v_mfma_f32_16x16x32_bf16 v[48:51], v[120:123], v[128:131], v[48:51]
    v_mfma_f32_16x16x32_bf16 v[52:55], v[120:123], v[132:135], v[52:55]
    v_mfma_f32_16x16x32_bf16 v[56:59], v[120:123], v[136:139], v[56:59]
    v_mfma_f32_16x16x32_bf16 v[60:63], v[120:123], v[140:143], v[60:63]
    v_mfma_f32_16x16x32_bf16 v[64:67], v[124:127], v[128:131], v[64:67]
    v_mfma_f32_16x16x32_bf16 v[68:71], v[124:127], v[132:135], v[68:71]
    v_mfma_f32_16x16x32_bf16 v[72:75], v[124:127], v[136:139], v[72:75]
    v_mfma_f32_16x16x32_bf16 v[76:79], v[124:127], v[140:143], v[76:79]
    s_cmp_ge_u32 s6, 4
    s_cbranch_scc1 L_k2_w18
    s_waitcnt vmcnt(6)
    s_branch L_k2_x18
L_k2_w18:
    s_waitcnt vmcnt(4)
L_k2_x18:
    s_barrier
    s_add_u32 m0, s24, 0
    s_nop 0
    global_load_lds_dwordx4 v4, s[12:13]
    s_add_u32 m0, s25, 0
    s_nop 0
    global_load_lds_dwordx4 v5, s[12:13]
    s_cmp_ge_u32 s6, 4
    s_cbranch_scc1 L_k2_d19
    s_add_u32 m0, s26, 0
    s_nop 0
    global_load_lds_dwordx4 v6, s[12:13]
L_k2_d19:
    s_add_u32 s12, s12, 1024
    s_addc_u32 s13, s13, 0
    ds_read_b128 v[112:115], v11 offset:0
    ds_read_b128 v[128:131], v12 offset:0
    ds_read_b128 v[116:119], v11 offset:1024
    ds_read_b128 v[132:135], v12 offset:1024
    ds_read_b128 v[120:123], v11 offset:2048
    ds_read_b128 v[136:139], v12 offset:2048
    ds_read_b128 v[124:127], v11 offset:3072
    ds_read_b128 v[140:143], v12 offset:3072
    s_waitcnt lgkmcnt(8)
    v_mfma_f32_16x16x32_bf16 v[16:19], v[80:83], v[96:99], v[16:19]
    v_mfma_f32_16x16x32_bf16 v[20:23], v[80:83], v[100:103], v[20:23]
    v_mfma_f32_16x16x32_bf16 v[24:27], v[80:83], v[104:107], v[24:27]
    v_mfma_f32_16x16x32_bf16 v[28:31], v[80:83], v[108:111], v[28:31]
    v_mfma_f32_16x16x32_bf16 v[32:35], v[84:87], v[96:99], v[32:35]
    v_mfma_f32_16x16x32_bf16 v[36:39], v[84:87], v[100:103], v[36:39]
    v_mfma_f32_16x16x32_bf16 v[40:43], v[84:87], v[104:107], v[40:43]
    v_mfma_f32_16x16x32_bf16 v[44:47], v[84:87], v[108:111], v[44:47]
    v_mfma_f32_16x16x32_bf16 v[48:51], v[88:91], v[96:99], v[48:51]
    v_mfma_f32_16x16x32_bf16 v[52:55], v[88:91], v[100:103], v[52:55]
    v_mfma_f32_16x16x32_bf16 v[56:59], v[88:91], v[104:107], v[56:59]
    v_mfma_f32_16x16x32_bf16 v[60:63], v[88:91], v[108:111], v[60:63]
    v_mfma_f32_16x16x32_bf16 v[64:67], v[92:95], v[96:99], v[64:67]
    v_mfma_f32_16x16x32_bf16 v[68:71], v[92:95], v[100:103], v[68:71]
    v_mfma_f32_16x16x32_bf16 v[72:75], v[92:95], v[104:107], v[72:75]
    v_mfma_f32_16x16x32_bf16 v[76:79], v[92:95], v[108:111], v[76:79]
    s_cmp_ge_u32 s6, 4
    s_cbranch_scc1 L_k2_w20
    s_waitcnt vmcnt(6)
    s_branch L_k2_x20
L_k2_w20:
    s_waitcnt vmcnt(4)
L_k2_x20:
    s_barrier
    s_add_u32 m0, s24, 28672
    s_nop 0
    global_load_lds_dwordx4 v4, s[12:13]
    s_add_u32 m0, s25, 28672
    s_nop 0
    global_load_lds_dwordx4 v5, s[12:13]
    s_cmp_ge_u32 s6, 4
    s_cbranch_scc1 L_k2_d21
    s_add_u32 m0, s26, 28672
    s_nop 0
    global_load_lds_dwordx4 v6, s[12:13]
L_k2_d21:
    s_add_u32 s12, s12, 1024
    s_addc_u32 s13, s13, 0
    ds_read_b128 v[80:83], v11 offset:28672
    ds_read_b128 v[96:99], v12 offset:28672
    ds_read_b128 v[84:87], v11 offset:29696
    ds_read_b128 v[100:103], v12 offset:29696
    ds_read_b128 v[88:91], v11 offset:30720
    ds_read_b128 v[104:107], v12 offset:30720
    ds_read_b128 v[92:95], v11 offset:31744
    ds_read_b128 v[108:111], v12 offset:31744
    s_waitcnt lgkmcnt(8)
    v_mfma_f32_16x16x32_bf16 v[16:19], v[112:115], v[128:131], v[16:19]
    v_mfma_f32_16x16x32_bf16 v[20:23], v[112:115], v[132:135], v[20:23]
    v_mfma_f32_16x16x32_bf16 v[24:27], v[112:115], v[136:139], v[24:27]
    v_mfma_f32_16x16x32_bf16 v[28:31], v[112:115], v[140:143], v[28:31]
    v_mfma_f32_16x16x32_bf16 v[32:35], v[116:119], v[128:131], v[32:35]
    v_mfma_f32_16x16x32_bf16 v[36:39], v[116:119], v[132:135], v[36:39]
    v_mfma_f32_16x16x32_bf16 v[40:43], v[116:119], v[136:139], v[40:43]
    v_mfma_f32_16x16x32_bf16 v[44:47], v[116:119], v[140:143], v[44:47]
    v_mfma_f32_16x16x32_bf16 v[48:51], v[120:123], v[128:131], v[48:51]
    v_mfma_f32_16x16x32_bf16 v[52:55], v[120:123], v[132:135], v[52:55]
    v_mfma_f32_16x16x32_bf16 v[56:59], v[120:123], v[136:139], v[56:59]
    v_mfma_f32_16x16x32_bf16 v[60:63], v[120:123], v[140:143], v[60:63]
    v_mfma_f32_16x16x32_bf16 v[64:67], v[124:127], v[128:131], v[64:67]
    v_mfma_f32_16x16x32_bf16 v[68:71], v[124:127], v[132:135], v[68:71]
    v_mfma_f32_16x16x32_bf16 v[72:75], v[124:127], v[136:139], v[72:75]
    v_mfma_f32_16x16x32_bf16 v[76:79], v[124:127], v[140:143], v[76:79]
    s_cmp_ge_u32 s6, 4
    s_cbranch_scc1 L_k2_w22
    s_waitcnt vmcnt(6)
    s_branch L_k2_x22
L_k2_w22:
    s_waitcnt vmcnt(4)
L_k2_x22:
    s_barrier
    s_add_u32 m0, s24, 57344
    s_nop 0
    global_load_lds_dwordx4 v4, s[12:13]
    s_add_u32 m0, s25, 57344
    s_nop 0
    global_load_lds_dwordx4 v5, s[12:13]
    s_cmp_ge_u32 s6, 4
    s_cbranch_scc1 L_k2_d23
    s_add_u32 m0, s26, 57344
    s_nop 0
    global_load_lds_dwordx4 v6, s[12:13]
L_k2_d23:
    s_add_u32 s12, s12, 1024
    s_addc_u32 s13, s13, 0
    ds_read_b128 v[112:115], v13 offset:0
    ds_read_b128 v[128:131], v14 offset:0
    ds_read_b128 v[116:119], v13 offset:1024
    ds_read_b128 v[132:135], v14 offset:1024
    ds_read_b128 v[120:123], v13 offset:2048
    ds_read_b128 v[136:139], v14 offset:2048
    ds_read_b128 v[124:127], v13 offset:3072
    ds_read_b128 v[140:143], v14 offset:3072
    s_waitcnt lgkmcnt(8)
    v_mfma_f32_16x16x32_bf16 v[16:19], v[80:83], v[96:99], v[16:19]
    v_mfma_f32_16x16x32_bf16 v[20:23], v[80:83], v[100:103], v[20:23]
    v_mfma_f32_16x16x32_bf16 v[24:27], v[80:83], v[104:107], v[24:27]
    v_mfma_f32_16x16x32_bf16 v[28:31], v[80:83], v[108:111], v[28:31]
    v_mfma_f32_16x16x32_bf16 v[32:35], v[84:87], v[96:99], v[32:35]
    v_mfma_f32_16x16x32_bf16 v[36:39], v[84:87], v[100:103], v[36:39]
    v_mfma_f32_16x16x32_bf16 v[40:43], v[84:87], v[104:107], v[40:43]
    v_mfma_f32_16x16x32_bf16 v[44:47], v[84:87], v[108:111], v[44:47]
    v_mfma_f32_16x16x32_bf16 v[48:51], v[88:91], v[96:99], v[48:51]
    v_mfma_f32_16x16x32_bf16 v[52:55], v[88:91], v[100:103], v[52:55]
    v_mfma_f32_16x16x32_bf16 v[56:59], v[88:91], v[104:107], v[56:59]
    v_mfma_f32_16x16x32_bf16 v[60:63], v[88:91], v[108:111], v[60:63]
    v_mfma_f32_16x16x32_bf16 v[64:67], v[92:95], v[96:99], v[64:67]
    v_mfma_f32_16x16x32_bf16 v[68:71], v[92:95], v[100:103], v[68:71]
    v_mfma_f32_16x16x32_bf16 v[72:75], v[92:95], v[104:107], v[72:75]
    v_mfma_f32_16x16x32_bf16 v[76:79], v[92:95], v[108:111], v[76:79]
    s_cmp_ge_u32 s6, 4
    s_cbranch_scc1 L_k2_w24
    s_waitcnt vmcnt(6)
    s_branch L_k2_x24
L_k2_w24:
    s_waitcnt vmcnt(4)
L_k2_x24:
    s_barrier
    s_add_u32 m0, s24, 86016
    s_nop 0
    global_load_lds_dwordx4 v4, s[12:13]
    s_add_u32 m0, s25, 86016
    s_nop 0
    global_load_lds_dwordx4 v5, s[12:13]
    s_cmp_ge_u32 s6, 4
    s_cbranch_scc1 L_k2_d25
    s_add_u32 m0, s26, 86016
    s_nop 0
    global_load_lds_dwordx4 v6, s[12:13]
L_k2_d25:
    s_add_u32 s12, s12, 1024
    s_addc_u32 s13, s13, 0
    ds_read_b128 v[80:83], v9 offset:0
    ds_read_b128 v[96:99], v10 offset:0
    ds_read_b128 v[84:87], v9 offset:1024
    ds_read_b128 v[100:103], v10 offset:1024
    ds_read_b128 v[88:91], v9 offset:2048
    ds_read_b128 v[104:107], v10 offset:2048
    ds_read_b128 v[92:95], v9 offset:3072
    ds_read_b128 v[108:111], v10 offset:3072
    s_waitcnt lgkmcnt(8)
    v_mfma_f32_16x16x32_bf16 v[16:19], v[112:115], v[128:131], v[16:19]
    v_mfma_f32_16x16x32_bf16 v[20:23], v[112:115], v[132:135], v[20:23]
    v_mfma_f32_16x16x32_bf16 v[24:27], v[112:115], v[136:139], v[24:27]
    v_mfma_f32_16x16x32_bf16 v[28:31], v[112:115], v[140:143], v[28:31]
    v_mfma_f32_16x16x32_bf16 v[32:35], v[116:119], v[128:131], v[32:35]
    v_mfma_f32_16x16x32_bf16 v[36:39], v[116:119], v[132:135], v[36:39]
    v_mfma_f32_16x16x32_bf16 v[40:43], v[116:119], v[136:139], v[40:43]
    v_mfma_f32_16x16x32_bf16 v[44:47], v[116:119], v[140:143], v[44:47]
    v_mfma_f32_16x16x32_bf16 v[48:51], v[120:123], v[128:131], v[48:51]
    v_mfma_f32_16x16x32_bf16 v[52:55], v[120:123], v[132:135], v[52:55]
    v_mfma_f32_16x16x32_bf16 v[56:59], v[120:123], v[136:139], v[56:59]
    v_mfma_f32_16x16x32_bf16 v[60:63], v[120:123], v[140:143], v[60:63]
    v_mfma_f32_16x16x32_bf16 v[64:67], v[124:127], v[128:131], v[64:67]
    v_mfma_f32_16x16x32_bf16 v[68:71], v[124:127], v[132:135], v[68:71]
    v_mfma_f32_16x16x32_bf16 v[72:75], v[124:127], v[136:139], v[72:75]
    v_mfma_f32_16x16x32_bf16 v[76:79], v[124:127], v[140:143], v[76:79]
    s_cmp_ge_u32 s6, 4
    s_cbranch_scc1 L_k2_w26
    s_waitcnt vmcnt(6)
    s_branch L_k2_x26
L_k2_w26:
    s_waitcnt vmcnt(4)
L_k2_x26:
    s_barrier
    s_add_u32 m0, s24, 114688
    s_nop 0
    global_load_lds_dwordx4 v4, s[12:13]
    s_add_u32 m0, s25, 114688
    s_nop 0
    global_load_lds_dwordx4 v5, s[12:13]
    s_cmp_ge_u32 s6, 4
    s_cbranch_scc1 L_k2_d27
    s_add_u32 m0, s26, 114688
    s_nop 0
    global_load_lds_dwordx4 v6, s[12:13]
L_k2_d27:
    s_add_u32 s12, s12, 1024
    s_addc_u32 s13, s13, 0
    ds_read_b128 v[112:115], v9 offset:28672
    ds_read_b128 v[128:131], v10 offset:28672
    ds_read_b128 v[116:119], v9 offset:29696
    ds_read_b128 v[132:135], v10 offset:29696
    ds_read_b128 v[120:123], v9 offset:30720
    ds_read_b128 v[136:139], v10 offset:30720
    ds_read_b128 v[124:127], v9 offset:31744
    ds_read_b128 v[140:143], v10 offset:31744
    s_waitcnt lgkmcnt(8)
    v_mfma_f32_16x16x32_bf16 v[16:19], v[80:83], v[96:99], v[16:19]
    v_mfma_f32_16x16x32_bf16 v[20:23], v[80:83], v[100:103], v[20:23]
    v_mfma_f32_16x16x32_bf16 v[24:27], v[80:83], v[104:107], v[24:27]
    v_mfma_f32_16x16x32_bf16 v[28:31], v[80:83], v[108:111], v[28:31]
    v_mfma_f32_16x16x32_bf16 v[32:35], v[84:87], v[96:99], v[32:35]
    v_mfma_f32_16x16x32_bf16 v[36:39], v[84:87], v[100:103], v[36:39]
    v_mfma_f32_16x16x32_bf16 v[40:43], v[84:87], v[104:107], v[40:43]
    v_mfma_f32_16x16x32_bf16 v[44:47], v[84:87], v[108:111], v[44:47]
    v_mfma_f32_16x16x32_bf16 v[48:51], v[88:91], v[96:99], v[48:51]
    v_mfma_f32_16x16x32_bf16 v[52:55], v[88:91], v[100:103], v[52:55]
    v_mfma_f32_16x16x32_bf16 v[56:59], v[88:91], v[104:107], v[56:59]
    v_mfma_f32_16x16x32_bf16 v[60:63], v[88:91], v[108:111], v[60:63]
    v_mfma_f32_16x16x32_bf16 v[64:67], v[92:95], v[96:99], v[64:67]
    v_mfma_f32_16x16x32_bf16 v[68:71], v[92:95], v[100:103], v[68:71]
    v_mfma_f32_16x16x32_bf16 v[72:75], v[92:95], v[104:107], v[72:75]
    v_mfma_f32_16x16x32_bf16 v[76:79], v[92:95], v[108:111], v[76:79]
    s_cmp_ge_u32 s6, 4
    s_cbranch_scc1 L_k2_w28
    s_waitcnt vmcnt(6)
    s_branch L_k2_x28
L_k2_w28:
    s_waitcnt vmcnt(4)
L_k2_x28:
    s_barrier
    s_add_u32 m0, s24, 0
    s_nop 0
    global_load_lds_dwordx4 v4, s[12:13]
    s_add_u32 m0, s25, 0
    s_nop 0
    global_load_lds_dwordx4 v5, s[12:13]
    s_cmp_ge_u32 s6, 4
    s_cbranch_scc1 L_k2_d29
    s_add_u32 m0, s26, 0
    s_nop 0
    global_load_lds_dwordx4 v6, s[12:13]
L_k2_d29:
    s_add_u32 s12, s12, 1024
    s_addc_u32 s13, s13, 0
    ds_read_b128 v[80:83], v11 offset:0
    ds_read_b128 v[96:99], v12 offset:0
    ds_read_b128 v[84:87], v11 offset:1024
    ds_read_b128 v[100:103], v12 offset:1024
    ds_read_b128 v[88:91], v11 offset:2048
    ds_read_b128 v[104:107], v12 offset:2048
    ds_read_b128 v[92:95], v11 offset:3072
    ds_read_b128 v[108:111], v12 offset:3072
    s_waitcnt lgkmcnt(8)
    v_mfma_f32_16x16x32_bf16 v[16:19], v[112:115], v[128:131], v[16:19]
    v_mfma_f32_16x16x32_bf16 v[20:23], v[112:115], v[132:135], v[20:23]
    v_mfma_f32_16x16x32_bf16 v[24:27], v[112:115], v[136:139], v[24:27]
    v_mfma_f32_16x16x32_bf16 v[28:31], v[112:115], v[140:143], v[28:31]
    v_mfma_f32_16x16x32_bf16 v[32:35], v[116:119], v[128:131], v[32:35]
    v_mfma_f32_16x16x32_bf16 v[36:39], v[116:119], v[132:135], v[36:39]
    v_mfma_f32_16x16x32_bf16 v[40:43], v[116:119], v[136:139], v[40:43]
    v_mfma_f32_16x16x32_bf16 v[44:47], v[116:119], v[140:143], v[44:47]
    v_mfma_f32_16x16x32_bf16 v[48:51], v[120:123], v[128:131], v[48:51]
    v_mfma_f32_16x16x32_bf16 v[52:55], v[120:123], v[132:135], v[52:55]
    v_mfma_f32_16x16x32_bf16 v[56:59], v[120:123], v[136:139], v[56:59]
    v_mfma_f32_16x16x32_bf16 v[60:63], v[120:123], v[140:143], v[60:63]
    v_mfma_f32_16x16x32_bf16 v[64:67], v[124:127], v[128:131], v[64:67]
    v_mfma_f32_16x16x32_bf16 v[68:71], v[124:127], v[132:135], v[68:71]
    v_mfma_f32_16x16x32_bf16 v[72:75], v[124:127], v[136:139], v[72:75]
    v_mfma_f32_16x16x32_bf16 v[76:79], v[124:127], v[140:143], v[76:79]
    s_cmp_ge_u32 s6, 4
    s_cbranch_scc1 L_k2_w30
    s_waitcnt vmcnt(6)
    s_branch L_k2_x30
L_k2_w30:
    s_waitcnt vmcnt(4)
L_k2_x30:
    s_barrier
    s_add_u32 m0, s24, 28672
    s_nop 0
    global_load_lds_dwordx4 v4, s[12:13]
    s_add_u32 m0, s25, 28672
    s_nop 0
    global_load_lds_dwordx4 v5, s[12:13]
    s_cmp_ge_u32 s6, 4
    s_cbranch_scc1 L_k2_d31
    s_add_u32 m0, s26, 28672
    s_nop 0
    global_load_lds_dwordx4 v6, s[12:13]
L_k2_d31:
    s_add_u32 s12, s12, 1024
    s_addc_u32 s13, s13, 0
    ds_read_b128 v[112:115], v11 offset:28672
    ds_read_b128 v[128:131], v12 offset:28672
    ds_read_b128 v[116:119], v11 offset:29696
    ds_read_b128 v[132:135], v12 offset:29696
    ds_read_b128 v[120:123], v11 offset:30720
    ds_read_b128 v[136:139], v12 offset:30720
    ds_read_b128 v[124:127], v11 offset:31744
    ds_read_b128 v[140:143], v12 offset:31744
    s_waitcnt lgkmcnt(8)
    v_mfma_f32_16x16x32_bf16 v[16:19], v[80:83], v[96:99], v[16:19]
    v_mfma_f32_16x16x32_bf16 v[20:23], v[80:83], v[100:103], v[20:23]
    v_mfma_f32_16x16x32_bf16 v[24:27], v[80:83], v[104:107], v[24:27]
    v_mfma_f32_16x16x32_bf16 v[28:31], v[80:83], v[108:111], v[28:31]
    v_mfma_f32_16x16x32_bf16 v[32:35], v[84:87], v[96:99], v[32:35]
    v_mfma_f32_16x16x32_bf16 v[36:39], v[84:87], v[100:103], v[36:39]
    v_mfma_f32_16x16x32_bf16 v[40:43], v[84:87], v[104:107], v[40:43]
    v_mfma_f32_16x16x32_bf16 v[44:47], v[84:87], v[108:111], v[44:47]
    v_mfma_f32_16x16x32_bf16 v[48:51], v[88:91], v[96:99], v[48:51]
    v_mfma_f32_16x16x32_bf16 v[52:55], v[88:91], v[100:103], v[52:55]
    v_mfma_f32_16x16x32_bf16 v[56:59], v[88:91], v[104:107], v[56:59]
    v_mfma_f32_16x16x32_bf16 v[60:63], v[88:91], v[108:111], v[60:63]
    v_mfma_f32_16x16x32_bf16 v[64:67], v[92:95], v[96:99], v[64:67]
    v_mfma_f32_16x16x32_bf16 v[68:71], v[92:95], v[100:103], v[68:71]
    v_mfma_f32_16x16x32_bf16 v[72:75], v[92:95], v[104:107], v[72:75]
    v_mfma_f32_16x16x32_bf16 v[76:79], v[92:95], v[108:111], v[76:79]
    s_cmp_ge_u32 s6, 4
    s_cbranch_scc1 L_k2_w32
    s_waitcnt vmcnt(6)
    s_branch L_k2_x32
L_k2_w32:
    s_waitcnt vmcnt(4)
L_k2_x32:
    s_barrier
    s_add_u32 m0, s24, 57344
    s_nop 0
    global_load_lds_dwordx4 v4, s[12:13]
    s_add_u32 m0, s25, 57344
    s_nop 0
    global_load_lds_dwordx4 v5, s[12:13]
    s_cmp_ge_u32 s6, 4
    s_cbranch_scc1 L_k2_d33
    s_add_u32 m0, s26, 57344
    s_nop 0
    global_load_lds_dwordx4 v6, s[12:13]
L_k2_d33:
    s_add_u32 s12, s12, 1024
    s_addc_u32 s13, s13, 0
    ds_read_b128 v[80:83], v13 offset:0
    ds_read_b128 v[96:99], v14 offset:0
    ds_read_b128 v[84:87], v13 offset:1024
    ds_read_b128 v[100:103], v14 offset:1024
    ds_read_b128 v[88:91], v13 offset:2048
    ds_read_b128 v[104:107], v14 offset:2048
    ds_read_b128 v[92:95], v13 offset:3072
    ds_read_b128 v[108:111], v14 offset:3072
    s_waitcnt lgkmcnt(8)
    v_mfma_f32_16x16x32_bf16 v[16:19], v[112:115], v[128:131], v[16:19]
    v_mfma_f32_16x16x32_bf16 v[20:23], v[112:115], v[132:135], v[20:23]
    v_mfma_f32_16x16x32_bf16 v[24:27], v[112:115], v[136:139], v[24:27]
    v_mfma_f32_16x16x32_bf16 v[28:31], v[112:115], v[140:143], v[28:31]
    v_mfma_f32_16x16x32_bf16 v[32:35], v[116:119], v[128:131], v[32:35]
    v_mfma_f32_16x16x32_bf16 v[36:39], v[116:119], v[132:135], v[36:39]
    v_mfma_f32_16x16x32_bf16 v[40:43], v[116:119], v[136:139], v[40:43]
    v_mfma_f32_16x16x32_bf16 v[44:47], v[116:119], v[140:143], v[44:47]
    v_mfma_f32_16x16x32_bf16 v[48:51], v[120:123], v[128:131], v[48:51]
    v_mfma_f32_16x16x32_bf16 v[52:55], v[120:123], v[132:135], v[52:55]
    v_mfma_f32_16x16x32_bf16 v[56:59], v[120:123], v[136:139], v[56:59]
    v_mfma_f32_16x16x32_bf16 v[60:63], v[120:123], v[140:143], v[60:63]
    v_mfma_f32_16x16x32_bf16 v[64:67], v[124:127], v[128:131], v[64:67]
    v_mfma_f32_16x16x32_bf16 v[68:71], v[124:127], v[132:135], v[68:71]
    v_mfma_f32_16x16x32_bf16 v[72:75], v[124:127], v[136:139], v[72:75]
    v_mfma_f32_16x16x32_bf16 v[76:79], v[124:127], v[140:143], v[76:79]
    s_cmp_ge_u32 s6, 4
    s_cbranch_scc1 L_k2_w34
    s_waitcnt vmcnt(6)
    s_branch L_k2_x34
L_k2_w34:
    s_waitcnt vmcnt(4)
L_k2_x34:
    s_barrier
    s_add_u32 m0, s24, 86016
    s_nop 0
    global_load_lds_dwordx4 v4, s[12:13]
    s_add_u32 m0, s25, 86016
    s_nop 0
    global_load_lds_dwordx4 v5, s[12:13]
    s_cmp_ge_u32 s6, 4
    s_cbranch_scc1 L_k2_d35
    s_add_u32 m0, s26, 86016
    s_nop 0
    global_load_lds_dwordx4 v6, s[12:13]
L_k2_d35:
    s_add_u32 s12, s12, 1024
    s_addc_u32 s13, s13, 0
    ds_read_b128 v[112:115], v9 offset:0
    ds_read_b128 v[128:131], v10 offset:0
    ds_read_b128 v[116:119], v9 offset:1024
    ds_read_b128 v[132:135], v10 offset:1024
    ds_read_b128 v[120:123], v9 offset:2048
    ds_read_b128 v[136:139], v10 offset:2048
    ds_read_b128 v[124:127], v9 offset:3072
    ds_read_b128 v[140:143], v10 offset:3072
    s_waitcnt lgkmcnt(8)
    v_mfma_f32_16x16x32_bf16 v[16:19], v[80:83], v[96:99], v[16:19]
    v_mfma_f32_16x16x32_bf16 v[20:23], v[80:83], v[100:103], v[20:23]
    v_mfma_f32_16x16x32_bf16 v[24:27], v[80:83], v[104:107], v[24:27]
    v_mfma_f32_16x16x32_bf16 v[28:31], v[80:83], v[108:111], v[28:31]
    v_mfma_f32_16x16x32_bf16 v[32:35], v[84:87], v[96:99], v[32:35]
    v_mfma_f32_16x16x32_bf16 v[36:39], v[84:87], v[100:103], v[36:39]
    v_mfma_f32_16x16x32_bf16 v[40:43], v[84:87], v[104:107], v[40:43]
    v_mfma_f32_16x16x32_bf16 v[44:47], v[84:87], v[108:111], v[44:47]
    v_mfma_f32_16x16x32_bf16 v[48:51], v[88:91], v[96:99], v[48:51]
    v_mfma_f32_16x16x32_bf16 v[52:55], v[88:91], v[100:103], v[52:55]
    v_mfma_f32_16x16x32_bf16 v[56:59], v[88:91], v[104:107], v[56:59]
    v_mfma_f32_16x16x32_bf16 v[60:63], v[88:91], v[108:111], v[60:63]
    v_mfma_f32_16x16x32_bf16 v[64:67], v[92:95], v[96:99], v[64:67]
    v_mfma_f32_16x16x32_bf16 v[68:71], v[92:95], v[100:103], v[68:71]
    v_mfma_f32_16x16x32_bf16 v[72:75], v[92:95], v[104:107], v[72:75]
    v_mfma_f32_16x16x32_bf16 v[76:79], v[92:95], v[108:111], v[76:79]
    s_cmp_ge_u32 s6, 4
    s_cbranch_scc1 L_k2_w36
    s_waitcnt vmcnt(6)
    s_branch L_k2_x36
L_k2_w36:
    s_waitcnt vmcnt(4)
L_k2_x36:
    s_barrier
    s_add_u32 m0, s24, 114688
    s_nop 0
    global_load_lds_dwordx4 v4, s[12:13]
    s_add_u32 m0, s25, 114688
    s_nop 0
    global_load_lds_dwordx4 v5, s[12:13]
    s_cmp_ge_u32 s6, 4
    s_cbranch_scc1 L_k2_d37
    s_add_u32 m0, s26, 114688
    s_nop 0
    global_load_lds_dwordx4 v6, s[12:13]
L_k2_d37:
    s_add_u32 s12, s12, 1024
    s_addc_u32 s13, s13, 0
    ds_read_b128 v[80:83], v9 offset:28672
    ds_read_b128 v[96:99], v10 offset:28672
    ds_read_b128 v[84:87], v9 offset:29696
    ds_read_b128 v[100:103], v10 offset:29696
    ds_read_b128 v[88:91], v9 offset:30720
    ds_read_b128 v[104:107], v10 offset:30720
    ds_read_b128 v[92:95], v9 offset:31744
    ds_read_b128 v[108:111], v10 offset:31744
    s_waitcnt lgkmcnt(8)
    v_mfma_f32_16x16x32_bf16 v[16:19], v[112:115], v[128:131], v[16:19]
    v_mfma_f32_16x16x32_bf16 v[20:23], v[112:115], v[132:135], v[20:23]
    v_mfma_f32_16x16x32_bf16 v[24:27], v[112:115], v[136:139], v[24:27]
    v_mfma_f32_16x16x32_bf16 v[28:31], v[112:115], v[140:143], v[28:31]
    v_mfma_f32_16x16x32_bf16 v[32:35], v[116:119], v[128:131], v[32:35]
    v_mfma_f32_16x16x32_bf16 v[36:39], v[116:119], v[132:135], v[36:39]
    v_mfma_f32_16x16x32_bf16 v[40:43], v[116:119], v[136:139], v[40:43]
    v_mfma_f32_16x16x32_bf16 v[44:47], v[116:119], v[140:143], v[44:47]
    v_mfma_f32_16x16x32_bf16 v[48:51], v[120:123], v[128:131], v[48:51]
    v_mfma_f32_16x16x32_bf16 v[52:55], v[120:123], v[132:135], v[52:55]
    v_mfma_f32_16x16x32_bf16 v[56:59], v[120:123], v[136:139], v[56:59]
    v_mfma_f32_16x16x32_bf16 v[60:63], v[120:123], v[140:143], v[60:63]
    v_mfma_f32_16x16x32_bf16 v[64:67], v[124:127], v[128:131], v[64:67]
    v_mfma_f32_16x16x32_bf16 v[68:71], v[124:127], v[132:135], v[68:71]
    v_mfma_f32_16x16x32_bf16 v[72:75], v[124:127], v[136:139], v[72:75]
    v_mfma_f32_16x16x32_bf16 v[76:79], v[124:127], v[140:143], v[76:79]
    s_cmp_ge_u32 s6, 4
    s_cbranch_scc1 L_k2_w38
    s_waitcnt vmcnt(6)
    s_branch L_k2_x38
L_k2_w38:
    s_waitcnt vmcnt(4)
L_k2_x38:
    s_barrier
    ds_read_b128 v[112:115], v11 offset:0
    ds_read_b128 v[128:131], v12 offset:0
    ds_read_b128 v[116:119], v11 offset:1024
    ds_read_b128 v[132:135], v12 offset:1024
    ds_read_b128 v[120:123], v11 offset:2048
    ds_read_b128 v[136:139], v12 offset:2048
    ds_read_b128 v[124:127], v11 offset:3072
    ds_read_b128 v[140:143], v12 offset:3072
    s_waitcnt lgkmcnt(8)
    v_mfma_f32_16x16x32_bf16 v[16:19], v[80:83], v[96:99], v[16:19]
    v_mfma_f32_16x16x32_bf16 v[20:23], v[80:83], v[100:103], v[20:23]
    v_mfma_f32_16x16x32_bf16 v[24:27], v[80:83], v[104:107], v[24:27]
    v_mfma_f32_16x16x32_bf16 v[28:31], v[80:83], v[108:111], v[28:31]
    v_mfma_f32_16x16x32_bf16 v[32:35], v[84:87], v[96:99], v[32:35]
    v_mfma_f32_16x16x32_bf16 v[36:39], v[84:87], v[100:103], v[36:39]
    v_mfma_f32_16x16x32_bf16 v[40:43], v[84:87], v[104:107], v[40:43]
    v_mfma_f32_16x16x32_bf16 v[44:47], v[84:87], v[108:111], v[44:47]
    v_mfma_f32_16x16x32_bf16 v[48:51], v[88:91], v[96:99], v[48:51]
    v_mfma_f32_16x16x32_bf16 v[52:55], v[88:91], v[100:103], v[52:55]
    v_mfma_f32_16x16x32_bf16 v[56:59], v[88:91], v[104:107], v[56:59]
    v_mfma_f32_16x16x32_bf16 v[60:63], v[88:91], v[108:111], v[60:63]
    v_mfma_f32_16x16x32_bf16 v[64:67], v[92:95], v[96:99], v[64:67]
    v_mfma_f32_16x16x32_bf16 v[68:71], v[92:95], v[100:103], v[68:71]
    v_mfma_f32_16x16x32_bf16 v[72:75], v[92:95], v[104:107], v[72:75]
    v_mfma_f32_16x16x32_bf16 v[76:79], v[92:95], v[108:111], v[76:79]
    s_cmp_ge_u32 s6, 4
    s_cbranch_scc1 L_k2_w39
    s_waitcnt vmcnt(3)
    s_branch L_k2_x39
L_k2_w39:
    s_waitcnt vmcnt(2)
L_k2_x39:
    s_barrier
    ds_read_b128 v[80:83], v11 offset:28672
    ds_read_b128 v[96:99], v12 offset:28672
    ds_read_b128 v[84:87], v11 offset:29696
    ds_read_b128 v[100:103], v12 offset:29696
    ds_read_b128 v[88:91], v11 offset:30720
    ds_read_b128 v[104:107], v12 offset:30720
    ds_read_b128 v[92:95], v11 offset:31744
    ds_read_b128 v[108:111], v12 offset:31744
    s_waitcnt lgkmcnt(8)
    v_mfma_f32_16x16x32_bf16 v[16:19], v[112:115], v[128:131], v[16:19]
    v_mfma_f32_16x16x32_bf16 v[20:23], v[112:115], v[132:135], v[20:23]
    v_mfma_f32_16x16x32_bf16 v[24:27], v[112:115], v[136:139], v[24:27]
    v_mfma_f32_16x16x32_bf16 v[28:31], v[112:115], v[140:143], v[28:31]
    v_mfma_f32_16x16x32_bf16 v[32:35], v[116:119], v[128:131], v[32:35]
    v_mfma_f32_16x16x32_bf16 v[36:39], v[116:119], v[132:135], v[36:39]
    v_mfma_f32_16x16x32_bf16 v[40:43], v[116:119], v[136:139], v[40:43]
    v_mfma_f32_16x16x32_bf16 v[44:47], v[116:119], v[140:143], v[44:47]
    v_mfma_f32_16x16x32_bf16 v[48:51], v[120:123], v[128:131], v[48:51]
    v_mfma_f32_16x16x32_bf16 v[52:55], v[120:123], v[132:135], v[52:55]
    v_mfma_f32_16x16x32_bf16 v[56:59], v[120:123], v[136:139], v[56:59]
    v_mfma_f32_16x16x32_bf16 v[60:63], v[120:123], v[140:143], v[60:63]
    v_mfma_f32_16x16x32_bf16 v[64:67], v[124:127], v[128:131], v[64:67]
    v_mfma_f32_16x16x32_bf16 v[68:71], v[124:127], v[132:135], v[68:71]
    v_mfma_f32_16x16x32_bf16 v[72:75], v[124:127], v[136:139], v[72:75]
    v_mfma_f32_16x16x32_bf16 v[76:79], v[124:127], v[140:143], v[76:79]
    s_waitcnt vmcnt(0)
    s_barrier
    ds_read_b128 v[112:115], v13 offset:0
    ds_read_b128 v[128:131], v14 offset:0
    ds_read_b128 v[116:119], v13 offset:1024
    ds_read_b128 v[132:135], v14 offset:1024
    ds_read_b128 v[120:123], v13 offset:2048
    ds_read_b128 v[136:139], v14 offset:2048
    ds_read_b128 v[124:127], v13 offset:3072
    ds_read_b128 v[140:143], v14 offset:3072
    s_waitcnt lgkmcnt(8)
    v_mfma_f32_16x16x32_bf16 v[16:19], v[80:83], v[96:99], v[16:19]
    v_mfma_f32_16x16x32_bf16 v[20:23], v[80:83], v[100:103], v[20:23]
    v_mfma_f32_16x16x32_bf16 v[24:27], v[80:83], v[104:107], v[24:27]
    v_mfma_f32_16x16x32_bf16 v[28:31], v[80:83], v[108:111], v[28:31]
    v_mfma_f32_16x16x32_bf16 v[32:35], v[84:87], v[96:99], v[32:35]
    v_mfma_f32_16x16x32_bf16 v[36:39], v[84:87], v[100:103], v[36:39]
    v_mfma_f32_16x16x32_bf16 v[40:43], v[84:87], v[104:107], v[40:43]
    v_mfma_f32_16x16x32_bf16 v[44:47], v[84:87], v[108:111], v[44:47]
    v_mfma_f32_16x16x32_bf16 v[48:51], v[88:91], v[96:99], v[48:51]
    v_mfma_f32_16x16x32_bf16 v[52:55], v[88:91], v[100:103], v[52:55]
    v_mfma_f32_16x16x32_bf16 v[56:59], v[88:91], v[104:107], v[56:59]
    v_mfma_f32_16x16x32_bf16 v[60:63], v[88:91], v[108:111], v[60:63]
    v_mfma_f32_16x16x32_bf16 v[64:67], v[92:95], v[96:99], v[64:67]
    v_mfma_f32_16x16x32_bf16 v[68:71], v[92:95], v[100:103], v[68:71]
    v_mfma_f32_16x16x32_bf16 v[72:75], v[92:95], v[104:107], v[72:75]
    v_mfma_f32_16x16x32_bf16 v[76:79], v[92:95], v[108:111], v[76:79]
    s_waitcnt lgkmcnt(0)
    v_mfma_f32_16x16x32_bf16 v[16:19], v[112:115], v[128:131], v[16:19]
    v_mfma_f32_16x16x32_bf16 v[20:23], v[112:115], v[132:135], v[20:23]
    v_mfma_f32_16x16x32_bf16 v[24:27], v[112:115], v[136:139], v[24:27]
    v_mfma_f32_16x16x32_bf16 v[28:31], v[112:115], v[140:143], v[28:31]
    v_mfma_f32_16x16x32_bf16 v[32:35], v[116:119], v[128:131], v[32:35]
    v_mfma_f32_16x16x32_bf16 v[36:39], v[116:119], v[132:135], v[36:39]
    v_mfma_f32_16x16x32_bf16 v[40:43], v[116:119], v[136:139], v[40:43]
    v_mfma_f32_16x16x32_bf16 v[44:47], v[116:119], v[140:143], v[44:47]
    v_mfma_f32_16x16x32_bf16 v[48:51], v[120:123], v[128:131], v[48:51]
    v_mfma_f32_16x16x32_bf16 v[52:55], v[120:123], v[132:135], v[52:55]
    v_mfma_f32_16x16x32_bf16 v[56:59], v[120:123], v[136:139], v[56:59]
    v_mfma_f32_16x16x32_bf16 v[60:63], v[120:123], v[140:143], v[60:63]
    v_mfma_f32_16x16x32_bf16 v[64:67], v[124:127], v[128:131], v[64:67]
    v_mfma_f32_16x16x32_bf16 v[68:71], v[124:127], v[132:135], v[68:71]
    v_mfma_f32_16x16x32_bf16 v[72:75], v[124:127], v[136:139], v[72:75]
    v_mfma_f32_16x16x32_bf16 v[76:79], v[124:127], v[140:143], v[76:79]
    s_nop 7
    s_nop 7
    s_lshl_b32 s20, s4, 4
    s_lshl_b32 s21, s8, 2
    s_add_u32 s20, s20, s21
    s_cmp_lt_u32 s5, 10
    s_cbranch_scc1 L_k2_qkv
    s_sub_u32 s21, s5, 10
    s_mul_i32 s21, s21, 3
    s_add_u32 s21, s21, s7
    s_add_u32 s21, s21, 20
    s_mul_i32 s22, s20, 74
    s_add_u32 s22, s22, s21
    s_lshl_b32 s22, s22, 10
    s_add_u32 s24, s18, 0x2000000
    s_addc_u32 s25, s19, 0
    s_add_u32 s24, s24, s22
    s_addc_u32 s25, s25, 0
    v_max_f32 v80, 0, v16
    v_mul_f32 v80, v80, v48
    v_max_f32 v81, 0, v17
    v_mul_f32 v81, v81, v49
    v_max_f32 v82, 0, v18
    v_mul_f32 v82, v82, v50
    v_max_f32 v83, 0, v19
    v_mul_f32 v83, v83, v51
    v_max_f32 v84, 0, v32
    v_mul_f32 v84, v84, v64
    v_max_f32 v85, 0, v33
    v_mul_f32 v85, v85, v65
    v_max_f32 v86, 0, v34
    v_mul_f32 v86, v86, v66
    v_max_f32 v87, 0, v35
    v_mul_f32 v87, v87, v67
    v_cvt_pk_bf16_f32 v88, v80, v81
    v_cvt_pk_bf16_f32 v89, v82, v83
    v_cvt_pk_bf16_f32 v90, v84, v85
    v_cvt_pk_bf16_f32 v91, v86, v87
    global_store_dwordx4 v3, v[88:91], s[24:25]
    s_add_u32 s24, s24, 75776
    s_addc_u32 s25, s25, 0
    v_max_f32 v80, 0, v20
    v_mul_f32 v80, v80, v52
    v_max_f32 v81, 0, v21
    v_mul_f32 v81, v81, v53
    v_max_f32 v82, 0, v22
    v_mul_f32 v82, v82, v54
    v_max_f32 v83, 0, v23
    v_mul_f32 v83, v83, v55
    v_max_f32 v84, 0, v36
    v_mul_f32 v84, v84, v68
    v_max_f32 v85, 0, v37
    v_mul_f32 v85, v85, v69
    v_max_f32 v86, 0, v38
    v_mul_f32 v86, v86, v70
    v_max_f32 v87, 0, v39
    v_mul_f32 v87, v87, v71
    v_cvt_pk_bf16_f32 v88, v80, v81
    v_cvt_pk_bf16_f32 v89, v82, v83
    v_cvt_pk_bf16_f32 v90, v84, v85
    v_cvt_pk_bf16_f32 v91, v86, v87
    global_store_dwordx4 v3, v[88:91], s[24:25]
    s_add_u32 s24, s24, 75776
    s_addc_u32 s25, s25, 0
    v_max_f32 v80, 0, v24
    v_mul_f32 v80, v80, v56
    v_max_f32 v81, 0, v25
    v_mul_f32 v81, v81, v57
    v_max_f32 v82, 0, v26
    v_mul_f32 v82, v82, v58
    v_max_f32 v83, 0, v27
    v_mul_f32 v83, v83, v59
    v_max_f32 v84, 0, v40
    v_mul_f32 v84, v84, v72
    v_max_f32 v85, 0, v41
    v_mul_f32 v85, v85, v73
    v_max_f32 v86, 0, v42
    v_mul_f32 v86, v86, v74
    v_max_f32 v87, 0, v43
    v_mul_f32 v87, v87, v75
    v_cvt_pk_bf16_f32 v88, v80, v81
    v_cvt_pk_bf16_f32 v89, v82, v83
    v_cvt_pk_bf16_f32 v90, v84, v85
    v_cvt_pk_bf16_f32 v91, v86, v87
    global_store_dwordx4 v3, v[88:91], s[24:25]
    s_add_u32 s24, s24, 75776
    s_addc_u32 s25, s25, 0
    v_max_f32 v80, 0, v28
    v_mul_f32 v80, v80, v60
    v_max_f32 v81, 0, v29
    v_mul_f32 v81, v81, v61
    v_max_f32 v82, 0, v30
    v_mul_f32 v82, v82, v62
    v_max_f32 v83, 0, v31
    v_mul_f32 v83, v83, v63
    v_max_f32 v84, 0, v44
    v_mul_f32 v84, v84, v76
    v_max_f32 v85, 0, v45
    v_mul_f32 v85, v85, v77
    v_max_f32 v86, 0, v46
    v_mul_f32 v86, v86, v78
    v_max_f32 v87, 0, v47
    v_mul_f32 v87, v87, v79
    v_cvt_pk_bf16_f32 v88, v80, v81
    v_cvt_pk_bf16_f32 v89, v82, v83
    v_cvt_pk_bf16_f32 v90, v84, v85
    v_cvt_pk_bf16_f32 v91, v86, v87
    global_store_dwordx4 v3, v[88:91], s[24:25]
    s_add_u32 s24, s24, 75776
    s_addc_u32 s25, s25, 0
    s_branch L_k2_end
L_k2_qkv:
    v_and_b32 v10, 15, v2
    v_mul_u32_u24 v10, 3840, v10
    v_lshrrev_b32 v11, 4, v2
    v_lshlrev_b32 v11, 4, v11
    v_add_u32 v10, v10, v11
    s_mul_i32 s22, s20, 61440
    s_mul_i32 s21, s5, 384
    s_add_u32 s22, s22, s21
    s_lshl_b32 s21, s7, 7
    s_add_u32 s22, s22, s21
    s_add_u32 s24, s18, 0x1000000
    s_addc_u32 s25, s19, 0
    s_add_u32 s24, s24, s22
    s_addc_u32 s25, s25, 0
    v_cvt_pk_bf16_f32 v80, v16, v17
    v_cvt_pk_bf16_f32 v81, v18, v19
    v_cvt_pk_bf16_f32 v82, v32, v33
    v_cvt_pk_bf16_f32 v83, v34, v35
    global_store_dwordx4 v10, v[80:83], s[24:25] offset:0
    v_cvt_pk_bf16_f32 v88, v48, v49
    v_cvt_pk_bf16_f32 v89, v50, v51
    v_cvt_pk_bf16_f32 v90, v64, v65
    v_cvt_pk_bf16_f32 v91, v66, v67
    global_store_dwordx4 v10, v[88:91], s[24:25] offset:64
    s_add_u32 s24, s24, 61440
    s_addc_u32 s25, s25, 0
    v_cvt_pk_bf16_f32 v80, v20, v21
    v_cvt_pk_bf16_f32 v81, v22, v23
    v_cvt_pk_bf16_f32 v82, v36, v37
    v_cvt_pk_bf16_f32 v83, v38, v39
    global_store_dwordx4 v10, v[80:83], s[24:25] offset:0
    v_cvt_pk_bf16_f32 v88, v52, v53
    v_cvt_pk_bf16_f32 v89, v54, v55
    v_cvt_pk_bf16_f32 v90, v68, v69
    v_cvt_pk_bf16_f32 v91, v70, v71
    global_store_dwordx4 v10, v[88:91], s[24:25] offset:64
    s_add_u32 s24, s24, 61440
    s_addc_u32 s25, s25, 0
    v_cvt_pk_bf16_f32 v80, v24, v25
    v_cvt_pk_bf16_f32 v81, v26, v27
    v_cvt_pk_bf16_f32 v82, v40, v41
    v_cvt_pk_bf16_f32 v83, v42, v43
    global_store_dwordx4 v10, v[80:83], s[24:25] offset:0
    v_cvt_pk_bf16_f32 v88, v56, v57
    v_cvt_pk_bf16_f32 v89, v58, v59
    v_cvt_pk_bf16_f32 v90, v72, v73
    v_cvt_pk_bf16_f32 v91, v74, v75
    global_store_dwordx4 v10, v[88:91], s[24:25] offset:64
    s_add_u32 s24, s24, 61440
    s_addc_u32 s25, s25, 0
    v_cvt_pk_bf16_f32 v80, v28, v29
    v_cvt_pk_bf16_f32 v81, v30, v31
    v_cvt_pk_bf16_f32 v82, v44, v45
    v_cvt_pk_bf16_f32 v83, v46, v47
    global_store_dwordx4 v10, v[80:83], s[24:25] offset:0
    v_cvt_pk_bf16_f32 v88, v60, v61
    v_cvt_pk_bf16_f32 v89, v62, v63
    v_cvt_pk_bf16_f32 v90, v76, v77
    v_cvt_pk_bf16_f32 v91, v78, v79
    global_store_dwordx4 v10, v[88:91], s[24:25] offset:64
    s_add_u32 s24, s24, 61440
    s_addc_u32 s25, s25, 0
L_k2_end:
    s_endpgm
.p2align 8
.globl k3_attn_kernel
.type k3_attn_kernel,@function
k3_attn_kernel:
    s_cmp_ge_u32 s2, 256
    s_cbranch_scc1 L_k3_end
    s_load_dwordx2 s[18:19], s[0:1], 72
    s_and_b32 s3, s2, 7
    s_lshl_b32 s3, s3, 5
    s_lshr_b32 s4, s2, 3
    s_add_u32 s3, s3, s4
    s_lshl_b32 s3, s3, 8
    v_add_u32 v1, s3, v0
    v_lshrrev_b32 v2, 5, v1
    v_and_b32 v3, 31, v1
    v_mul_u32_u24 v4, 40, v3
    v_mul_u32_u24 v5, 3840, v2
    v_add_u32 v5, v5, v4
    s_waitcnt lgkmcnt(0)
    s_add_u32 s20, s18, 0x1000000
    s_addc_u32 s21, s19, 0
    global_load_dwordx2 v[8:9], v5, s[20:21] offset:0
    global_load_dwordx2 v[10:11], v5, s[20:21] offset:8
    global_load_dwordx2 v[12:13], v5, s[20:21] offset:16
    global_load_dwordx2 v[14:15], v5, s[20:21] offset:24
    global_load_dwordx2 v[16:17], v5, s[20:21] offset:32
    v_subrev_u32 v6, 0, v2
    v_max_i32 v6, 0, v6
    v_mul_u32_u24 v6, 3840, v6
    v_add_u32 v6, v6, v4
    global_load_dwordx2 v[20:21], v6, s[20:21] offset:1280
    global_load_dwordx2 v[22:23], v6, s[20:21] offset:1288
    global_load_dwordx2 v[24:25], v6, s[20:21] offset:1296
    global_load_dwordx2 v[26:27], v6, s[20:21] offset:1304
    global_load_dwordx2 v[28:29], v6, s[20:21] offset:1312
    global_load_dwordx2 v[100:101], v6, s[20:21] offset:2560
    global_load_dwordx2 v[102:103], v6, s[20:21] offset:2568
    global_load_dwordx2 v[104:105], v6, s[20:21] offset:2576
    global_load_dwordx2 v[106:107], v6, s[20:21] offset:2584
    global_load_dwordx2 v[108:109], v6, s[20:21] offset:2592
    v_subrev_u32 v6, 2, v2
    v_max_i32 v6, 0, v6
    v_mul_u32_u24 v6, 3840, v6
    v_add_u32 v6, v6, v4
    global_load_dwordx2 v[30:31], v6, s[20:21] offset:1280
    global_load_dwordx2 v[32:33], v6, s[20:21] offset:1288
    global_load_dwordx2 v[34:35], v6, s[20:21] offset:1296
    global_load_dwordx2 v[36:37], v6, s[20:21] offset:1304
    global_load_dwordx2 v[38:39], v6, s[20:21] offset:1312
    global_load_dwordx2 v[110:111], v6, s[20:21] offset:2560
    global_load_dwordx2 v[112:113], v6, s[20:21] offset:2568
    global_load_dwordx2 v[114:115], v6, s[20:21] offset:2576
    global_load_dwordx2 v[116:117], v6, s[20:21] offset:2584
    global_load_dwordx2 v[118:119], v6, s[20:21] offset:2592
    v_subrev_u32 v6, 4, v2
    v_max_i32 v6, 0, v6
    v_mul_u32_u24 v6, 3840, v6
    v_add_u32 v6, v6, v4
    global_load_dwordx2 v[40:41], v6, s[20:21] offset:1280
    global_load_dwordx2 v[42:43], v6, s[20:21] offset:1288
    global_load_dwordx2 v[44:45], v6, s[20:21] offset:1296
    global_load_dwordx2 v[46:47], v6, s[20:21] offset:1304
    global_load_dwordx2 v[48:49], v6, s[20:21] offset:1312
    global_load_dwordx2 v[120:121], v6, s[20:21] offset:2560
    global_load_dwordx2 v[122:123], v6, s[20:21] offset:2568
    global_load_dwordx2 v[124:125], v6, s[20:21] offset:2576
    global_load_dwordx2 v[126:127], v6, s[20:21] offset:2584
    global_load_dwordx2 v[128:129], v6, s[20:21] offset:2592
    v_subrev_u32 v6, 6, v2
    v_max_i32 v6, 0, v6
    v_mul_u32_u24 v6, 3840, v6
    v_add_u32 v6, v6, v4
    global_load_dwordx2 v[50:51], v6, s[20:21] offset:1280
    global_load_dwordx2 v[52:53], v6, s[20:21] offset:1288
    global_load_dwordx2 v[54:55], v6, s[20:21] offset:1296
    global_load_dwordx2 v[56:57], v6, s[20:21] offset:1304
    global_load_dwordx2 v[58:59], v6, s[20:21] offset:1312
    global_load_dwordx2 v[130:131], v6, s[20:21] offset:2560
    global_load_dwordx2 v[132:133], v6, s[20:21] offset:2568
    global_load_dwordx2 v[134:135], v6, s[20:21] offset:2576
    global_load_dwordx2 v[136:137], v6, s[20:21] offset:2584
    global_load_dwordx2 v[138:139], v6, s[20:21] offset:2592
    v_subrev_u32 v6, 8, v2
    v_max_i32 v6, 0, v6
    v_mul_u32_u24 v6, 3840, v6
    v_add_u32 v6, v6, v4
    global_load_dwordx2 v[60:61], v6, s[20:21] offset:1280
    global_load_dwordx2 v[62:63], v6, s[20:21] offset:1288
    global_load_dwordx2 v[64:65], v6, s[20:21] offset:1296
    global_load_dwordx2 v[66:67], v6, s[20:21] offset:1304
    global_load_dwordx2 v[68:69], v6, s[20:21] offset:1312
    global_load_dwordx2 v[140:141], v6, s[20:21] offset:2560
    global_load_dwordx2 v[142:143], v6, s[20:21] offset:2568
    global_load_dwordx2 v[144:145], v6, s[20:21] offset:2576
    global_load_dwordx2 v[146:147], v6, s[20:21] offset:2584
    global_load_dwordx2 v[148:149], v6, s[20:21] offset:2592
    v_subrev_u32 v6, 10, v2
    v_max_i32 v6, 0, v6
    v_mul_u32_u24 v6, 3840, v6
    v_add_u32 v6, v6, v4
    global_load_dwordx2 v[70:71], v6, s[20:21] offset:1280
    global_load_dwordx2 v[72:73], v6, s[20:21] offset:1288
    global_load_dwordx2 v[74:75], v6, s[20:21] offset:1296
    global_load_dwordx2 v[76:77], v6, s[20:21] offset:1304
    global_load_dwordx2 v[78:79], v6, s[20:21] offset:1312
    global_load_dwordx2 v[150:151], v6, s[20:21] offset:2560
    global_load_dwordx2 v[152:153], v6, s[20:21] offset:2568
    global_load_dwordx2 v[154:155], v6, s[20:21] offset:2576
    global_load_dwordx2 v[156:157], v6, s[20:21] offset:2584
    global_load_dwordx2 v[158:159], v6, s[20:21] offset:2592
    v_subrev_u32 v6, 12, v2
    v_max_i32 v6, 0, v6
    v_mul_u32_u24 v6, 3840, v6
    v_add_u32 v6, v6, v4
    global_load_dwordx2 v[80:81], v6, s[20:21] offset:1280
    global_load_dwordx2 v[82:83], v6, s[20:21] offset:1288
    global_load_dwordx2 v[84:85], v6, s[20:21] offset:1296
    global_load_dwordx2 v[86:87], v6, s[20:21] offset:1304
    global_load_dwordx2 v[88:89], v6, s[20:21] offset:1312
    global_load_dwordx2 v[160:161], v6, s[20:21] offset:2560
    global_load_dwordx2 v[162:163], v6, s[20:21] offset:2568
    global_load_dwordx2 v[164:165], v6, s[20:21] offset:2576
    global_load_dwordx2 v[166:167], v6, s[20:21] offset:2584
    global_load_dwordx2 v[168:169], v6, s[20:21] offset:2592
    v_subrev_u32 v6, 14, v2
    v_max_i32 v6, 0, v6
    v_mul_u32_u24 v6, 3840, v6
    v_add_u32 v6, v6, v4
    global_load_dwordx2 v[90:91], v6, s[20:21] offset:1280
    global_load_dwordx2 v[92:93], v6, s[20:21] offset:1288
    global_load_dwordx2 v[94:95], v6, s[20:21] offset:1296
    global_load_dwordx2 v[96:97], v6, s[20:21] offset:1304
    global_load_dwordx2 v[98:99], v6, s[20:21] offset:1312
    global_load_dwordx2 v[170:171], v6, s[20:21] offset:2560
    global_load_dwordx2 v[172:173], v6, s[20:21] offset:2568
    global_load_dwordx2 v[174:175], v6, s[20:21] offset:2576
    global_load_dwordx2 v[176:177], v6, s[20:21] offset:2584
    global_load_dwordx2 v[178:179], v6, s[20:21] offset:2592
    s_waitcnt vmcnt(0)
    v_dot2_f32_bf16 v180, v8, v20, 0
    v_dot2_f32_bf16 v180, v9, v21, v180
    v_dot2_f32_bf16 v180, v10, v22, v180
    v_dot2_f32_bf16 v180, v11, v23, v180
    v_dot2_f32_bf16 v180, v12, v24, v180
    v_dot2_f32_bf16 v180, v13, v25, v180
    v_dot2_f32_bf16 v180, v14, v26, v180
    v_dot2_f32_bf16 v180, v15, v27, v180
    v_dot2_f32_bf16 v180, v16, v28, v180
    v_dot2_f32_bf16 v180, v17, v29, v180
    v_dot2_f32_bf16 v181, v8, v30, 0
    v_dot2_f32_bf16 v181, v9, v31, v181
    v_dot2_f32_bf16 v181, v10, v32, v181
    v_dot2_f32_bf16 v181, v11, v33, v181
    v_dot2_f32_bf16 v181, v12, v34, v181
    v_dot2_f32_bf16 v181, v13, v35, v181
    v_dot2_f32_bf16 v181, v14, v36, v181
    v_dot2_f32_bf16 v181, v15, v37, v181
    v_dot2_f32_bf16 v181, v16, v38, v181
    v_dot2_f32_bf16 v181, v17, v39, v181
    v_dot2_f32_bf16 v182, v8, v40, 0
    v_dot2_f32_bf16 v182, v9, v41, v182
    v_dot2_f32_bf16 v182, v10, v42, v182
    v_dot2_f32_bf16 v182, v11, v43, v182
    v_dot2_f32_bf16 v182, v12, v44, v182
    v_dot2_f32_bf16 v182, v13, v45, v182
    v_dot2_f32_bf16 v182, v14, v46, v182
    v_dot2_f32_bf16 v182, v15, v47, v182
    v_dot2_f32_bf16 v182, v16, v48, v182
    v_dot2_f32_bf16 v182, v17, v49, v182
    v_dot2_f32_bf16 v183, v8, v50, 0
    v_dot2_f32_bf16 v183, v9, v51, v183
    v_dot2_f32_bf16 v183, v10, v52, v183
    v_dot2_f32_bf16 v183, v11, v53, v183
    v_dot2_f32_bf16 v183, v12, v54, v183
    v_dot2_f32_bf16 v183, v13, v55, v183
    v_dot2_f32_bf16 v183, v14, v56, v183
    v_dot2_f32_bf16 v183, v15, v57, v183
    v_dot2_f32_bf16 v183, v16, v58, v183
    v_dot2_f32_bf16 v183, v17, v59, v183
    v_dot2_f32_bf16 v184, v8, v60, 0
    v_dot2_f32_bf16 v184, v9, v61, v184
    v_dot2_f32_bf16 v184, v10, v62, v184
    v_dot2_f32_bf16 v184, v11, v63, v184
    v_dot2_f32_bf16 v184, v12, v64, v184
    v_dot2_f32_bf16 v184, v13, v65, v184
    v_dot2_f32_bf16 v184, v14, v66, v184
    v_dot2_f32_bf16 v184, v15, v67, v184
    v_dot2_f32_bf16 v184, v16, v68, v184
    v_dot2_f32_bf16 v184, v17, v69, v184
    v_dot2_f32_bf16 v185, v8, v70, 0
    v_dot2_f32_bf16 v185, v9, v71, v185
    v_dot2_f32_bf16 v185, v10, v72, v185
    v_dot2_f32_bf16 v185, v11, v73, v185
    v_dot2_f32_bf16 v185, v12, v74, v185
    v_dot2_f32_bf16 v185, v13, v75, v185
    v_dot2_f32_bf16 v185, v14, v76, v185
    v_dot2_f32_bf16 v185, v15, v77, v185
    v_dot2_f32_bf16 v185, v16, v78, v185
    v_dot2_f32_bf16 v185, v17, v79, v185
    v_dot2_f32_bf16 v186, v8, v80, 0
    v_dot2_f32_bf16 v186, v9, v81, v186
    v_dot2_f32_bf16 v186, v10, v82, v186
    v_dot2_f32_bf16 v186, v11, v83, v186
    v_dot2_f32_bf16 v186, v12, v84, v186
    v_dot2_f32_bf16 v186, v13, v85, v186
    v_dot2_f32_bf16 v186, v14, v86, v186
    v_dot2_f32_bf16 v186, v15, v87, v186
    v_dot2_f32_bf16 v186, v16, v88, v186
    v_dot2_f32_bf16 v186, v17, v89, v186
    v_dot2_f32_bf16 v187, v8, v90, 0
    v_dot2_f32_bf16 v187, v9, v91, v187
    v_dot2_f32_bf16 v187, v10, v92, v187
    v_dot2_f32_bf16 v187, v11, v93, v187
    v_dot2_f32_bf16 v187, v12, v94, v187
    v_dot2_f32_bf16 v187, v13, v95, v187
    v_dot2_f32_bf16 v187, v14, v96, v187
    v_dot2_f32_bf16 v187, v15, v97, v187
    v_dot2_f32_bf16 v187, v16, v98, v187
    v_dot2_f32_bf16 v187, v17, v99, v187
    s_mov_b32 s4, 0x3ea52ef5
    v_mov_b32 v7, 0xff7fffff
    v_mul_f32 v180, s4, v180
    v_mul_f32 v181, s4, v181
    v_cmp_le_u32 vcc, 2, v2
    s_nop 1
    v_cndmask_b32 v181, v7, v181, vcc
    v_mul_f32 v182, s4, v182
    v_cmp_le_u32 vcc, 4, v2
    s_nop 1
    v_cndmask_b32 v182, v7, v182, vcc
    v_mul_f32 v183, s4, v183
    v_cmp_le_u32 vcc, 6, v2
    s_nop 1
    v_cndmask_b32 v183, v7, v183, vcc
    v_mul_f32 v184, s4, v184
    v_cmp_le_u32 vcc, 8, v2
    s_nop 1
    v_cndmask_b32 v184, v7, v184, vcc
    v_mul_f32 v185, s4, v185
    v_cmp_le_u32 vcc, 10, v2
    s_nop 1
    v_cndmask_b32 v185, v7, v185, vcc
    v_mul_f32 v186, s4, v186
    v_cmp_le_u32 vcc, 12, v2
    s_nop 1
    v_cndmask_b32 v186, v7, v186, vcc
    v_mul_f32 v187, s4, v187
    v_cmp_le_u32 vcc, 14, v2
    s_nop 1
    v_cndmask_b32 v187, v7, v187, vcc
    v_max3_f32 v6, v180, v181, v182
    v_max3_f32 v6, v6, v183, v184
    v_max3_f32 v6, v6, v185, v186
    v_max_f32 v6, v6, v187
    v_sub_f32 v180, v180, v6
    v_sub_f32 v181, v181, v6
    v_sub_f32 v182, v182, v6
    v_sub_f32 v183, v183, v6
    v_sub_f32 v184, v184, v6
    v_sub_f32 v185, v185, v6
    v_sub_f32 v186, v186, v6
    v_sub_f32 v187, v187, v6
    v_exp_f32 v180, v180
    v_exp_f32 v181, v181
    v_exp_f32 v182, v182
    v_exp_f32 v183, v183
    v_exp_f32 v184, v184
    v_exp_f32 v185, v185
    v_exp_f32 v186, v186
    v_exp_f32 v187, v187
    s_nop 0
    v_add_f32 v6, v180, v181
    v_add_f32 v6, v6, v182
    v_add_f32 v6, v6, v183
    v_add_f32 v6, v6, v184
    v_add_f32 v6, v6, v185
    v_add_f32 v6, v6, v186
    v_add_f32 v6, v6, v187
    v_rcp_f32 v6, v6
    s_nop 0
    v_mul_f32 v180, v180, v6
    v_mul_f32 v181, v181, v6
    v_mul_f32 v182, v182, v6
    v_mul_f32 v183, v183, v6
    v_mul_f32 v184, v184, v6
    v_mul_f32 v185, v185, v6
    v_mul_f32 v186, v186, v6
    v_mul_f32 v187, v187, v6
    v_lshlrev_b32 v6, 16, v100
    v_and_b32 v7, 0xffff0000, v100
    v_mul_f32 v20, v180, v6
    v_mul_f32 v21, v180, v7
    v_lshlrev_b32 v6, 16, v101
    v_and_b32 v7, 0xffff0000, v101
    v_mul_f32 v22, v180, v6
    v_mul_f32 v23, v180, v7
    v_lshlrev_b32 v6, 16, v102
    v_and_b32 v7, 0xffff0000, v102
    v_mul_f32 v24, v180, v6
    v_mul_f32 v25, v180, v7
    v_lshlrev_b32 v6, 16, v103
    v_and_b32 v7, 0xffff0000, v103
    v_mul_f32 v26, v180, v6
    v_mul_f32 v27, v180, v7
    v_lshlrev_b32 v6, 16, v104
    v_and_b32 v7, 0xffff0000, v104
    v_mul_f32 v28, v180, v6
    v_mul_f32 v29, v180, v7
    v_lshlrev_b32 v6, 16, v105
    v_and_b32 v7, 0xffff0000, v105
    v_mul_f32 v30, v180, v6
    v_mul_f32 v31, v180, v7
    v_lshlrev_b32 v6, 16, v106
    v_and_b32 v7, 0xffff0000, v106
    v_mul_f32 v32, v180, v6
    v_mul_f32 v33, v180, v7
    v_lshlrev_b32 v6, 16, v107
    v_and_b32 v7, 0xffff0000, v107
    v_mul_f32 v34, v180, v6
    v_mul_f32 v35, v180, v7
    v_lshlrev_b32 v6, 16, v108
    v_and_b32 v7, 0xffff0000, v108
    v_mul_f32 v36, v180, v6
    v_mul_f32 v37, v180, v7
    v_lshlrev_b32 v6, 16, v109
    v_and_b32 v7, 0xffff0000, v109
    v_mul_f32 v38, v180, v6
    v_mul_f32 v39, v180, v7
    v_lshlrev_b32 v6, 16, v110
    v_and_b32 v7, 0xffff0000, v110
    v_fmac_f32 v20, v181, v6
    v_fmac_f32 v21, v181, v7
    v_lshlrev_b32 v6, 16, v111
    v_and_b32 v7, 0xffff0000, v111
    v_fmac_f32 v22, v181, v6
    v_fmac_f32 v23, v181, v7
    v_lshlrev_b32 v6, 16, v112
    v_and_b32 v7, 0xffff0000, v112
    v_fmac_f32 v24, v181, v6
    v_fmac_f32 v25, v181, v7
    v_lshlrev_b32 v6, 16, v113
    v_and_b32 v7, 0xffff0000, v113
    v_fmac_f32 v26, v181, v6
    v_fmac_f32 v27, v181, v7
    v_lshlrev_b32 v6, 16, v114
    v_and_b32 v7, 0xffff0000, v114
    v_fmac_f32 v28, v181, v6
    v_fmac_f32 v29, v181, v7
    v_lshlrev_b32 v6, 16, v115
    v_and_b32 v7, 0xffff0000, v115
    v_fmac_f32 v30, v181, v6
    v_fmac_f32 v31, v181, v7
    v_lshlrev_b32 v6, 16, v116
    v_and_b32 v7, 0xffff0000, v116
    v_fmac_f32 v32, v181, v6
    v_fmac_f32 v33, v181, v7
    v_lshlrev_b32 v6, 16, v117
    v_and_b32 v7, 0xffff0000, v117
    v_fmac_f32 v34, v181, v6
    v_fmac_f32 v35, v181, v7
    v_lshlrev_b32 v6, 16, v118
    v_and_b32 v7, 0xffff0000, v118
    v_fmac_f32 v36, v181, v6
    v_fmac_f32 v37, v181, v7
    v_lshlrev_b32 v6, 16, v119
    v_and_b32 v7, 0xffff0000, v119
    v_fmac_f32 v38, v181, v6
    v_fmac_f32 v39, v181, v7
    v_lshlrev_b32 v6, 16, v120
    v_and_b32 v7, 0xffff0000, v120
    v_fmac_f32 v20, v182, v6
    v_fmac_f32 v21, v182, v7
    v_lshlrev_b32 v6, 16, v121
    v_and_b32 v7, 0xffff0000, v121
    v_fmac_f32 v22, v182, v6
    v_fmac_f32 v23, v182, v7
    v_lshlrev_b32 v6, 16, v122
    v_and_b32 v7, 0xffff0000, v122
    v_fmac_f32 v24, v182, v6
    v_fmac_f32 v25, v182, v7
    v_lshlrev_b32 v6, 16, v123
    v_and_b32 v7, 0xffff0000, v123
    v_fmac_f32 v26, v182, v6
    v_fmac_f32 v27, v182, v7
    v_lshlrev_b32 v6, 16, v124
    v_and_b32 v7, 0xffff0000, v124
    v_fmac_f32 v28, v182, v6
    v_fmac_f32 v29, v182, v7
    v_lshlrev_b32 v6, 16, v125
    v_and_b32 v7, 0xffff0000, v125
    v_fmac_f32 v30, v182, v6
    v_fmac_f32 v31, v182, v7
    v_lshlrev_b32 v6, 16, v126
    v_and_b32 v7, 0xffff0000, v126
    v_fmac_f32 v32, v182, v6
    v_fmac_f32 v33, v182, v7
    v_lshlrev_b32 v6, 16, v127
    v_and_b32 v7, 0xffff0000, v127
    v_fmac_f32 v34, v182, v6
    v_fmac_f32 v35, v182, v7
    v_lshlrev_b32 v6, 16, v128
    v_and_b32 v7, 0xffff0000, v128
    v_fmac_f32 v36, v182, v6
    v_fmac_f32 v37, v182, v7
    v_lshlrev_b32 v6, 16, v129
    v_and_b32 v7, 0xffff0000, v129
    v_fmac_f32 v38, v182, v6
    v_fmac_f32 v39, v182, v7
    v_lshlrev_b32 v6, 16, v130
    v_and_b32 v7, 0xffff0000, v130
    v_fmac_f32 v20, v183, v6
    v_fmac_f32 v21, v183, v7
    v_lshlrev_b32 v6, 16, v131
    v_and_b32 v7, 0xffff0000, v131
    v_fmac_f32 v22, v183, v6
    v_fmac_f32 v23, v183, v7
    v_lshlrev_b32 v6, 16, v132
    v_and_b32 v7, 0xffff0000, v132
    v_fmac_f32 v24, v183, v6
    v_fmac_f32 v25, v183, v7
    v_lshlrev_b32 v6, 16, v133
    v_and_b32 v7, 0xffff0000, v133
    v_fmac_f32 v26, v183, v6
    v_fmac_f32 v27, v183, v7
    v_lshlrev_b32 v6, 16, v134
    v_and_b32 v7, 0xffff0000, v134
    v_fmac_f32 v28, v183, v6
    v_fmac_f32 v29, v183, v7
    v_lshlrev_b32 v6, 16, v135
    v_and_b32 v7, 0xffff0000, v135
    v_fmac_f32 v30, v183, v6
    v_fmac_f32 v31, v183, v7
    v_lshlrev_b32 v6, 16, v136
    v_and_b32 v7, 0xffff0000, v136
    v_fmac_f32 v32, v183, v6
    v_fmac_f32 v33, v183, v7
    v_lshlrev_b32 v6, 16, v137
    v_and_b32 v7, 0xffff0000, v137
    v_fmac_f32 v34, v183, v6
    v_fmac_f32 v35, v183, v7
    v_lshlrev_b32 v6, 16, v138
    v_and_b32 v7, 0xffff0000, v138
    v_fmac_f32 v36, v183, v6
    v_fmac_f32 v37, v183, v7
    v_lshlrev_b32 v6, 16, v139
    v_and_b32 v7, 0xffff0000, v139
    v_fmac_f32 v38, v183, v6
    v_fmac_f32 v39, v183, v7
    v_lshlrev_b32 v6, 16, v140
    v_and_b32 v7, 0xffff0000, v140
    v_fmac_f32 v20, v184, v6
    v_fmac_f32 v21, v184, v7
    v_lshlrev_b32 v6, 16, v141
    v_and_b32 v7, 0xffff0000, v141
    v_fmac_f32 v22, v184, v6
    v_fmac_f32 v23, v184, v7
    v_lshlrev_b32 v6, 16, v142
    v_and_b32 v7, 0xffff0000, v142
    v_fmac_f32 v24, v184, v6
    v_fmac_f32 v25, v184, v7
    v_lshlrev_b32 v6, 16, v143
    v_and_b32 v7, 0xffff0000, v143
    v_fmac_f32 v26, v184, v6
    v_fmac_f32 v27, v184, v7
    v_lshlrev_b32 v6, 16, v144
    v_and_b32 v7, 0xffff0000, v144
    v_fmac_f32 v28, v184, v6
    v_fmac_f32 v29, v184, v7
    v_lshlrev_b32 v6, 16, v145
    v_and_b32 v7, 0xffff0000, v145
    v_fmac_f32 v30, v184, v6
    v_fmac_f32 v31, v184, v7
    v_lshlrev_b32 v6, 16, v146
    v_and_b32 v7, 0xffff0000, v146
    v_fmac_f32 v32, v184, v6
    v_fmac_f32 v33, v184, v7
    v_lshlrev_b32 v6, 16, v147
    v_and_b32 v7, 0xffff0000, v147
    v_fmac_f32 v34, v184, v6
    v_fmac_f32 v35, v184, v7
    v_lshlrev_b32 v6, 16, v148
    v_and_b32 v7, 0xffff0000, v148
    v_fmac_f32 v36, v184, v6
    v_fmac_f32 v37, v184, v7
    v_lshlrev_b32 v6, 16, v149
    v_and_b32 v7, 0xffff0000, v149
    v_fmac_f32 v38, v184, v6
    v_fmac_f32 v39, v184, v7
    v_lshlrev_b32 v6, 16, v150
    v_and_b32 v7, 0xffff0000, v150
    v_fmac_f32 v20, v185, v6
    v_fmac_f32 v21, v185, v7
    v_lshlrev_b32 v6, 16, v151
    v_and_b32 v7, 0xffff0000, v151
    v_fmac_f32 v22, v185, v6
    v_fmac_f32 v23, v185, v7
    v_lshlrev_b32 v6, 16, v152
    v_and_b32 v7, 0xffff0000, v152
    v_fmac_f32 v24, v185, v6
    v_fmac_f32 v25, v185, v7
    v_lshlrev_b32 v6, 16, v153
    v_and_b32 v7, 0xffff0000, v153
    v_fmac_f32 v26, v185, v6
    v_fmac_f32 v27, v185, v7
    v_lshlrev_b32 v6, 16, v154
    v_and_b32 v7, 0xffff0000, v154
    v_fmac_f32 v28, v185, v6
    v_fmac_f32 v29, v185, v7
    v_lshlrev_b32 v6, 16, v155
    v_and_b32 v7, 0xffff0000, v155
    v_fmac_f32 v30, v185, v6
    v_fmac_f32 v31, v185, v7
    v_lshlrev_b32 v6, 16, v156
    v_and_b32 v7, 0xffff0000, v156
    v_fmac_f32 v32, v185, v6
    v_fmac_f32 v33, v185, v7
    v_lshlrev_b32 v6, 16, v157
    v_and_b32 v7, 0xffff0000, v157
    v_fmac_f32 v34, v185, v6
    v_fmac_f32 v35, v185, v7
    v_lshlrev_b32 v6, 16, v158
    v_and_b32 v7, 0xffff0000, v158
    v_fmac_f32 v36, v185, v6
    v_fmac_f32 v37, v185, v7
    v_lshlrev_b32 v6, 16, v159
    v_and_b32 v7, 0xffff0000, v159
    v_fmac_f32 v38, v185, v6
    v_fmac_f32 v39, v185, v7
    v_lshlrev_b32 v6, 16, v160
    v_and_b32 v7, 0xffff0000, v160
    v_fmac_f32 v20, v186, v6
    v_fmac_f32 v21, v186, v7
    v_lshlrev_b32 v6, 16, v161
    v_and_b32 v7, 0xffff0000, v161
    v_fmac_f32 v22, v186, v6
    v_fmac_f32 v23, v186, v7
    v_lshlrev_b32 v6, 16, v162
    v_and_b32 v7, 0xffff0000, v162
    v_fmac_f32 v24, v186, v6
    v_fmac_f32 v25, v186, v7
    v_lshlrev_b32 v6, 16, v163
    v_and_b32 v7, 0xffff0000, v163
    v_fmac_f32 v26, v186, v6
    v_fmac_f32 v27, v186, v7
    v_lshlrev_b32 v6, 16, v164
    v_and_b32 v7, 0xffff0000, v164
    v_fmac_f32 v28, v186, v6
    v_fmac_f32 v29, v186, v7
    v_lshlrev_b32 v6, 16, v165
    v_and_b32 v7, 0xffff0000, v165
    v_fmac_f32 v30, v186, v6
    v_fmac_f32 v31, v186, v7
    v_lshlrev_b32 v6, 16, v166
    v_and_b32 v7, 0xffff0000, v166
    v_fmac_f32 v32, v186, v6
    v_fmac_f32 v33, v186, v7
    v_lshlrev_b32 v6, 16, v167
    v_and_b32 v7, 0xffff0000, v167
    v_fmac_f32 v34, v186, v6
    v_fmac_f32 v35, v186, v7
    v_lshlrev_b32 v6, 16, v168
    v_and_b32 v7, 0xffff0000, v168
    v_fmac_f32 v36, v186, v6
    v_fmac_f32 v37, v186, v7
    v_lshlrev_b32 v6, 16, v169
    v_and_b32 v7, 0xffff0000, v169
    v_fmac_f32 v38, v186, v6
    v_fmac_f32 v39, v186, v7
    v_lshlrev_b32 v6, 16, v170
    v_and_b32 v7, 0xffff0000, v170
    v_fmac_f32 v20, v187, v6
    v_fmac_f32 v21, v187, v7
    v_lshlrev_b32 v6, 16, v171
    v_and_b32 v7, 0xffff0000, v171
    v_fmac_f32 v22, v187, v6
    v_fmac_f32 v23, v187, v7
    v_lshlrev_b32 v6, 16, v172
    v_and_b32 v7, 0xffff0000, v172
    v_fmac_f32 v24, v187, v6
    v_fmac_f32 v25, v187, v7
    v_lshlrev_b32 v6, 16, v173
    v_and_b32 v7, 0xffff0000, v173
    v_fmac_f32 v26, v187, v6
    v_fmac_f32 v27, v187, v7
    v_lshlrev_b32 v6, 16, v174
    v_and_b32 v7, 0xffff0000, v174
    v_fmac_f32 v28, v187, v6
    v_fmac_f32 v29, v187, v7
    v_lshlrev_b32 v6, 16, v175
    v_and_b32 v7, 0xffff0000, v175
    v_fmac_f32 v30, v187, v6
    v_fmac_f32 v31, v187, v7
    v_lshlrev_b32 v6, 16, v176
    v_and_b32 v7, 0xffff0000, v176
    v_fmac_f32 v32, v187, v6
    v_fmac_f32 v33, v187, v7
    v_lshlrev_b32 v6, 16, v177
    v_and_b32 v7, 0xffff0000, v177
    v_fmac_f32 v34, v187, v6
    v_fmac_f32 v35, v187, v7
    v_lshlrev_b32 v6, 16, v178
    v_and_b32 v7, 0xffff0000, v178
    v_fmac_f32 v36, v187, v6
    v_fmac_f32 v37, v187, v7
    v_lshlrev_b32 v6, 16, v179
    v_and_b32 v7, 0xffff0000, v179
    v_fmac_f32 v38, v187, v6
    v_fmac_f32 v39, v187, v7
    v_cvt_pk_bf16_f32 v40, v20, v21
    v_cvt_pk_bf16_f32 v41, v22, v23
    v_cvt_pk_bf16_f32 v42, v24, v25
    v_cvt_pk_bf16_f32 v43, v26, v27
    v_cvt_pk_bf16_f32 v44, v28, v29
    v_cvt_pk_bf16_f32 v45, v30, v31
    v_cvt_pk_bf16_f32 v46, v32, v33
    v_cvt_pk_bf16_f32 v47, v34, v35
    v_cvt_pk_bf16_f32 v48, v36, v37
    v_cvt_pk_bf16_f32 v49, v38, v39
    s_add_u32 s20, s18, 0x2000000
    s_addc_u32 s21, s19, 0
    v_lshrrev_b32 v6, 4, v2
    v_mul_u32_u24 v6, 75776, v6
    v_and_b32 v7, 15, v2
    v_lshlrev_b32 v7, 4, v7
    v_add_u32 v6, v6, v7
    v_mul_u32_u24 v4, 20, v3
    v_add_u32 v7, 0, v4
    v_lshrrev_b32 v50, 5, v7
    v_lshlrev_b32 v50, 10, v50
    v_bfe_u32 v51, v7, 3, 2
    v_lshlrev_b32 v51, 8, v51
    v_add3_u32 v50, v50, v51, v6
    v_and_b32 v51, 4, v7
    v_lshlrev_b32 v51, 1, v51
    v_add_u32 v50, v50, v51
    global_store_dwordx2 v50, v[40:41], s[20:21]
    s_nop 1
    v_add_u32 v7, 4, v4
    v_lshrrev_b32 v50, 5, v7
    v_lshlrev_b32 v50, 10, v50
    v_bfe_u32 v51, v7, 3, 2
    v_lshlrev_b32 v51, 8, v51
    v_add3_u32 v50, v50, v51, v6
    v_and_b32 v51, 4, v7
    v_lshlrev_b32 v51, 1, v51
    v_add_u32 v50, v50, v51
    global_store_dwordx2 v50, v[42:43], s[20:21]
    s_nop 1
    v_add_u32 v7, 8, v4
    v_lshrrev_b32 v50, 5, v7
    v_lshlrev_b32 v50, 10, v50
    v_bfe_u32 v51, v7, 3, 2
    v_lshlrev_b32 v51, 8, v51
    v_add3_u32 v50, v50, v51, v6
    v_and_b32 v51, 4, v7
    v_lshlrev_b32 v51, 1, v51
    v_add_u32 v50, v50, v51
    global_store_dwordx2 v50, v[44:45], s[20:21]
    s_nop 1
    v_add_u32 v7, 12, v4
    v_lshrrev_b32 v50, 5, v7
    v_lshlrev_b32 v50, 10, v50
    v_bfe_u32 v51, v7, 3, 2
    v_lshlrev_b32 v51, 8, v51
    v_add3_u32 v50, v50, v51, v6
    v_and_b32 v51, 4, v7
    v_lshlrev_b32 v51, 1, v51
    v_add_u32 v50, v50, v51
    global_store_dwordx2 v50, v[46:47], s[20:21]
    s_nop 1
    v_add_u32 v7, 16, v4
    v_lshrrev_b32 v50, 5, v7
    v_lshlrev_b32 v50, 10, v50
    v_bfe_u32 v51, v7, 3, 2
    v_lshlrev_b32 v51, 8, v51
    v_add3_u32 v50, v50, v51, v6
    v_and_b32 v51, 4, v7
    v_lshlrev_b32 v51, 1, v51
    v_add_u32 v50, v50, v51
    global_store_dwordx2 v50, v[48:49], s[20:21]
    s_nop 1
L_k3_end:
    s_endpgm
.p2align 8
.globl k4_gemm2_kernel
.type k4_gemm2_kernel,@function
k4_gemm2_kernel:
    s_cmp_ge_u32 s2, 256
    s_cbranch_scc1 L_k4_end
    s_load_dwordx2 s[18:19], s[0:1], 72
    s_load_dwordx2 s[20:21], s[0:1], 0
    s_load_dwordx2 s[22:23], s[0:1], 56
    s_bfe_u32 s4, s2, 0x20001
    s_lshl_b32 s4, s4, 3
    s_lshr_b32 s5, s2, 5
    s_add_u32 s4, s4, s5
    s_and_b32 s5, s2, 1
    s_lshl_b32 s5, s5, 2
    s_bfe_u32 s7, s2, 0x20003
    s_add_u32 s5, s5, s7
    v_lshrrev_b32 v1, 6, v0
    v_and_b32 v2, 63, v0
    s_nop 0
    v_readfirstlane_b32 s6, v1
    v_lshlrev_b32 v3, 4, v2
    v_add_u32 v4, 0, v3
    v_add_u32 v5, 75776, v3
    v_add_u32 v6, 151552, v3
    v_add_u32 v7, 227328, v3
    v_add_u32 v8, 303104, v3
    v_add_u32 v9, 0, v3
    v_add_u32 v10, 75776, v3
    v_add_u32 v11, 151552, v3
    v_add_u32 v12, 227328, v3
    s_waitcnt lgkmcnt(0)
    s_mul_i32 s7, s5, 370
    s_add_u32 s7, s7, s6
    s_lshl_b32 s7, s7, 10
    s_add_u32 s8, s18, 0xc00000
    s_addc_u32 s9, s19, 0
    s_add_u32 s8, s8, s7
    s_addc_u32 s9, s9, 0
    s_mul_i32 s7, s4, 296
    s_add_u32 s7, s7, s6
    s_lshl_b32 s7, s7, 10
    s_add_u32 s10, s18, 0x2000000
    s_addc_u32 s11, s19, 0
    s_add_u32 s10, s10, s7
    s_addc_u32 s11, s11, 0
    global_load_dwordx4 v[96:99], v4, s[8:9]
    global_load_dwordx4 v[100:103], v5, s[8:9]
    global_load_dwordx4 v[104:107], v6, s[8:9]
    global_load_dwordx4 v[108:111], v7, s[8:9]
    global_load_dwordx4 v[112:115], v8, s[8:9]
    global_load_dwordx4 v[116:119], v9, s[10:11]
    global_load_dwordx4 v[120:123], v10, s[10:11]
    global_load_dwordx4 v[124:127], v11, s[10:11]
    global_load_dwordx4 v[128:131], v12, s[10:11]
    s_add_u32 s8, s8, 4096
    s_addc_u32 s9, s9, 0
    s_add_u32 s10, s10, 4096
    s_addc_u32 s11, s11, 0
    global_load_dwordx4 v[132:135], v4, s[8:9]
    global_load_dwordx4 v[136:139], v5, s[8:9]
    global_load_dwordx4 v[140:143], v6, s[8:9]
    global_load_dwordx4 v[144:147], v7, s[8:9]
    global_load_dwordx4 v[148:151], v8, s[8:9]
    global_load_dwordx4 v[152:155], v9, s[10:11]
    global_load_dwordx4 v[156:159], v10, s[10:11]
    global_load_dwordx4 v[160:163], v11, s[10:11]
    global_load_dwordx4 v[164:167], v12, s[10:11]
    s_add_u32 s8, s8, 4096
    s_addc_u32 s9, s9, 0
    s_add_u32 s10, s10, 4096
    s_addc_u32 s11, s11, 0
    global_load_dwordx4 v[168:171], v4, s[8:9]
    global_load_dwordx4 v[172:175], v5, s[8:9]
    global_load_dwordx4 v[176:179], v6, s[8:9]
    global_load_dwordx4 v[180:183], v7, s[8:9]
    global_load_dwordx4 v[184:187], v8, s[8:9]
    global_load_dwordx4 v[188:191], v9, s[10:11]
    global_load_dwordx4 v[192:195], v10, s[10:11]
    global_load_dwordx4 v[196:199], v11, s[10:11]
    global_load_dwordx4 v[200:203], v12, s[10:11]
    s_add_u32 s8, s8, 4096
    s_addc_u32 s9, s9, 0
    s_add_u32 s10, s10, 4096
    s_addc_u32 s11, s11, 0
    global_load_dwordx4 v[204:207], v4, s[8:9]
    global_load_dwordx4 v[208:211], v5, s[8:9]
    global_load_dwordx4 v[212:215], v6, s[8:9]
    global_load_dwordx4 v[216:219], v7, s[8:9]
    global_load_dwordx4 v[220:223], v8, s[8:9]
    global_load_dwordx4 v[224:227], v9, s[10:11]
    global_load_dwordx4 v[228:231], v10, s[10:11]
    global_load_dwordx4 v[232:235], v11, s[10:11]
    global_load_dwordx4 v[236:239], v12, s[10:11]
    s_add_u32 s8, s8, 4096
    s_addc_u32 s9, s9, 0
    s_add_u32 s10, s10, 4096
    s_addc_u32 s11, s11, 0
    s_waitcnt vmcnt(27)
    v_mfma_f32_16x16x32_bf16 v[16:19], v[96:99], v[116:119], 0
    v_mfma_f32_16x16x32_bf16 v[20:23], v[96:99], v[120:123], 0
    v_mfma_f32_16x16x32_bf16 v[24:27], v[96:99], v[124:127], 0
    v_mfma_f32_16x16x32_bf16 v[28:31], v[96:99], v[128:131], 0
    v_mfma_f32_16x16x32_bf16 v[32:35], v[100:103], v[116:119], 0
    v_mfma_f32_16x16x32_bf16 v[36:39], v[100:103], v[120:123], 0
    v_mfma_f32_16x16x32_bf16 v[40:43], v[100:103], v[124:127], 0
    v_mfma_f32_16x16x32_bf16 v[44:47], v[100:103], v[128:131], 0
    v_mfma_f32_16x16x32_bf16 v[48:51], v[104:107], v[116:119], 0
    v_mfma_f32_16x16x32_bf16 v[52:55], v[104:107], v[120:123], 0
    v_mfma_f32_16x16x32_bf16 v[56:59], v[104:107], v[124:127], 0
    v_mfma_f32_16x16x32_bf16 v[60:63], v[104:107], v[128:131], 0
    v_mfma_f32_16x16x32_bf16 v[64:67], v[108:111], v[116:119], 0
    v_mfma_f32_16x16x32_bf16 v[68:71], v[108:111], v[120:123], 0
    v_mfma_f32_16x16x32_bf16 v[72:75], v[108:111], v[124:127], 0
    v_mfma_f32_16x16x32_bf16 v[76:79], v[108:111], v[128:131], 0
    v_mfma_f32_16x16x32_bf16 v[80:83], v[112:115], v[116:119], 0
    v_mfma_f32_16x16x32_bf16 v[84:87], v[112:115], v[120:123], 0
    v_mfma_f32_16x16x32_bf16 v[88:91], v[112:115], v[124:127], 0
    v_mfma_f32_16x16x32_bf16 v[92:95], v[112:115], v[128:131], 0
    global_load_dwordx4 v[96:99], v4, s[8:9]
    global_load_dwordx4 v[100:103], v5, s[8:9]
    global_load_dwordx4 v[104:107], v6, s[8:9]
    global_load_dwordx4 v[108:111], v7, s[8:9]
    global_load_dwordx4 v[112:115], v8, s[8:9]
    global_load_dwordx4 v[116:119], v9, s[10:11]
    global_load_dwordx4 v[120:123], v10, s[10:11]
    global_load_dwordx4 v[124:127], v11, s[10:11]
    global_load_dwordx4 v[128:131], v12, s[10:11]
    s_add_u32 s8, s8, 4096
    s_addc_u32 s9, s9, 0
    s_add_u32 s10, s10, 4096
    s_addc_u32 s11, s11, 0
    s_waitcnt vmcnt(27)
    v_mfma_f32_16x16x32_bf16 v[16:19], v[132:135], v[152:155], v[16:19]
    v_mfma_f32_16x16x32_bf16 v[20:23], v[132:135], v[156:159], v[20:23]
    v_mfma_f32_16x16x32_bf16 v[24:27], v[132:135], v[160:163], v[24:27]
    v_mfma_f32_16x16x32_bf16 v[28:31], v[132:135], v[164:167], v[28:31]
    v_mfma_f32_16x16x32_bf16 v[32:35], v[136:139], v[152:155], v[32:35]
    v_mfma_f32_16x16x32_bf16 v[36:39], v[136:139], v[156:159], v[36:39]
    v_mfma_f32_16x16x32_bf16 v[40:43], v[136:139], v[160:163], v[40:43]
    v_mfma_f32_16x16x32_bf16 v[44:47], v[136:139], v[164:167], v[44:47]
    v_mfma_f32_16x16x32_bf16 v[48:51], v[140:143], v[152:155], v[48:51]
    v_mfma_f32_16x16x32_bf16 v[52:55], v[140:143], v[156:159], v[52:55]
    v_mfma_f32_16x16x32_bf16 v[56:59], v[140:143], v[160:163], v[56:59]
    v_mfma_f32_16x16x32_bf16 v[60:63], v[140:143], v[164:167], v[60:63]
    v_mfma_f32_16x16x32_bf16 v[64:67], v[144:147], v[152:155], v[64:67]
    v_mfma_f32_16x16x32_bf16 v[68:71], v[144:147], v[156:159], v[68:71]
    v_mfma_f32_16x16x32_bf16 v[72:75], v[144:147], v[160:163], v[72:75]
    v_mfma_f32_16x16x32_bf16 v[76:79], v[144:147], v[164:167], v[76:79]
    v_mfma_f32_16x16x32_bf16 v[80:83], v[148:151], v[152:155], v[80:83]
    v_mfma_f32_16x16x32_bf16 v[84:87], v[148:151], v[156:159], v[84:87]
    v_mfma_f32_16x16x32_bf16 v[88:91], v[148:151], v[160:163], v[88:91]
    v_mfma_f32_16x16x32_bf16 v[92:95], v[148:151], v[164:167], v[92:95]
    global_load_dwordx4 v[132:135], v4, s[8:9]
    global_load_dwordx4 v[136:139], v5, s[8:9]
    global_load_dwordx4 v[140:143], v6, s[8:9]
    global_load_dwordx4 v[144:147], v7, s[8:9]
    global_load_dwordx4 v[148:151], v8, s[8:9]
    global_load_dwordx4 v[152:155], v9, s[10:11]
    global_load_dwordx4 v[156:159], v10, s[10:11]
    global_load_dwordx4 v[160:163], v11, s[10:11]
    global_load_dwordx4 v[164:167], v12, s[10:11]
    s_add_u32 s8, s8, 4096
    s_addc_u32 s9, s9, 0
    s_add_u32 s10, s10, 4096
    s_addc_u32 s11, s11, 0
    s_waitcnt vmcnt(27)
    v_mfma_f32_16x16x32_bf16 v[16:19], v[168:171], v[188:191], v[16:19]
    v_mfma_f32_16x16x32_bf16 v[20:23], v[168:171], v[192:195], v[20:23]
    v_mfma_f32_16x16x32_bf16 v[24:27], v[168:171], v[196:199], v[24:27]
    v_mfma_f32_16x16x32_bf16 v[28:31], v[168:171], v[200:203], v[28:31]
    v_mfma_f32_16x16x32_bf16 v[32:35], v[172:175], v[188:191], v[32:35]
    v_mfma_f32_16x16x32_bf16 v[36:39], v[172:175], v[192:195], v[36:39]
    v_mfma_f32_16x16x32_bf16 v[40:43], v[172:175], v[196:199], v[40:43]
    v_mfma_f32_16x16x32_bf16 v[44:47], v[172:175], v[200:203], v[44:47]
    v_mfma_f32_16x16x32_bf16 v[48:51], v[176:179], v[188:191], v[48:51]
    v_mfma_f32_16x16x32_bf16 v[52:55], v[176:179], v[192:195], v[52:55]
    v_mfma_f32_16x16x32_bf16 v[56:59], v[176:179], v[196:199], v[56:59]
    v_mfma_f32_16x16x32_bf16 v[60:63], v[176:179], v[200:203], v[60:63]
    v_mfma_f32_16x16x32_bf16 v[64:67], v[180:183], v[188:191], v[64:67]
    v_mfma_f32_16x16x32_bf16 v[68:71], v[180:183], v[192:195], v[68:71]
    v_mfma_f32_16x16x32_bf16 v[72:75], v[180:183], v[196:199], v[72:75]
    v_mfma_f32_16x16x32_bf16 v[76:79], v[180:183], v[200:203], v[76:79]
    v_mfma_f32_16x16x32_bf16 v[80:83], v[184:187], v[188:191], v[80:83]
    v_mfma_f32_16x16x32_bf16 v[84:87], v[184:187], v[192:195], v[84:87]
    v_mfma_f32_16x16x32_bf16 v[88:91], v[184:187], v[196:199], v[88:91]
    v_mfma_f32_16x16x32_bf16 v[92:95], v[184:187], v[200:203], v[92:95]
    global_load_dwordx4 v[168:171], v4, s[8:9]
    global_load_dwordx4 v[172:175], v5, s[8:9]
    global_load_dwordx4 v[176:179], v6, s[8:9]
    global_load_dwordx4 v[180:183], v7, s[8:9]
    global_load_dwordx4 v[184:187], v8, s[8:9]
    global_load_dwordx4 v[188:191], v9, s[10:11]
    global_load_dwordx4 v[192:195], v10, s[10:11]
    global_load_dwordx4 v[196:199], v11, s[10:11]
    global_load_dwordx4 v[200:203], v12, s[10:11]
    s_add_u32 s8, s8, 4096
    s_addc_u32 s9, s9, 0
    s_add_u32 s10, s10, 4096
    s_addc_u32 s11, s11, 0
    s_waitcnt vmcnt(27)
    v_mfma_f32_16x16x32_bf16 v[16:19], v[204:207], v[224:227], v[16:19]
    v_mfma_f32_16x16x32_bf16 v[20:23], v[204:207], v[228:231], v[20:23]
    v_mfma_f32_16x16x32_bf16 v[24:27], v[204:207], v[232:235], v[24:27]
    v_mfma_f32_16x16x32_bf16 v[28:31], v[204:207], v[236:239], v[28:31]
    v_mfma_f32_16x16x32_bf16 v[32:35], v[208:211], v[224:227], v[32:35]
    v_mfma_f32_16x16x32_bf16 v[36:39], v[208:211], v[228:231], v[36:39]
    v_mfma_f32_16x16x32_bf16 v[40:43], v[208:211], v[232:235], v[40:43]
    v_mfma_f32_16x16x32_bf16 v[44:47], v[208:211], v[236:239], v[44:47]
    v_mfma_f32_16x16x32_bf16 v[48:51], v[212:215], v[224:227], v[48:51]
    v_mfma_f32_16x16x32_bf16 v[52:55], v[212:215], v[228:231], v[52:55]
    v_mfma_f32_16x16x32_bf16 v[56:59], v[212:215], v[232:235], v[56:59]
    v_mfma_f32_16x16x32_bf16 v[60:63], v[212:215], v[236:239], v[60:63]
    v_mfma_f32_16x16x32_bf16 v[64:67], v[216:219], v[224:227], v[64:67]
    v_mfma_f32_16x16x32_bf16 v[68:71], v[216:219], v[228:231], v[68:71]
    v_mfma_f32_16x16x32_bf16 v[72:75], v[216:219], v[232:235], v[72:75]
    v_mfma_f32_16x16x32_bf16 v[76:79], v[216:219], v[236:239], v[76:79]
    v_mfma_f32_16x16x32_bf16 v[80:83], v[220:223], v[224:227], v[80:83]
    v_mfma_f32_16x16x32_bf16 v[84:87], v[220:223], v[228:231], v[84:87]
    v_mfma_f32_16x16x32_bf16 v[88:91], v[220:223], v[232:235], v[88:91]
    v_mfma_f32_16x16x32_bf16 v[92:95], v[220:223], v[236:239], v[92:95]
    global_load_dwordx4 v[204:207], v4, s[8:9]
    global_load_dwordx4 v[208:211], v5, s[8:9]
    global_load_dwordx4 v[212:215], v6, s[8:9]
    global_load_dwordx4 v[216:219], v7, s[8:9]
    global_load_dwordx4 v[220:223], v8, s[8:9]
    global_load_dwordx4 v[224:227], v9, s[10:11]
    global_load_dwordx4 v[228:231], v10, s[10:11]
    global_load_dwordx4 v[232:235], v11, s[10:11]
    global_load_dwordx4 v[236:239], v12, s[10:11]
    s_add_u32 s8, s8, 4096
    s_addc_u32 s9, s9, 0
    s_add_u32 s10, s10, 4096
    s_addc_u32 s11, s11, 0
    s_waitcnt vmcnt(27)
    v_mfma_f32_16x16x32_bf16 v[16:19], v[96:99], v[116:119], v[16:19]
    v_mfma_f32_16x16x32_bf16 v[20:23], v[96:99], v[120:123], v[20:23]
    v_mfma_f32_16x16x32_bf16 v[24:27], v[96:99], v[124:127], v[24:27]
    v_mfma_f32_16x16x32_bf16 v[28:31], v[96:99], v[128:131], v[28:31]
    v_mfma_f32_16x16x32_bf16 v[32:35], v[100:103], v[116:119], v[32:35]
    v_mfma_f32_16x16x32_bf16 v[36:39], v[100:103], v[120:123], v[36:39]
    v_mfma_f32_16x16x32_bf16 v[40:43], v[100:103], v[124:127], v[40:43]
    v_mfma_f32_16x16x32_bf16 v[44:47], v[100:103], v[128:131], v[44:47]
    v_mfma_f32_16x16x32_bf16 v[48:51], v[104:107], v[116:119], v[48:51]
    v_mfma_f32_16x16x32_bf16 v[52:55], v[104:107], v[120:123], v[52:55]
    v_mfma_f32_16x16x32_bf16 v[56:59], v[104:107], v[124:127], v[56:59]
    v_mfma_f32_16x16x32_bf16 v[60:63], v[104:107], v[128:131], v[60:63]
    v_mfma_f32_16x16x32_bf16 v[64:67], v[108:111], v[116:119], v[64:67]
    v_mfma_f32_16x16x32_bf16 v[68:71], v[108:111], v[120:123], v[68:71]
    v_mfma_f32_16x16x32_bf16 v[72:75], v[108:111], v[124:127], v[72:75]
    v_mfma_f32_16x16x32_bf16 v[76:79], v[108:111], v[128:131], v[76:79]
    v_mfma_f32_16x16x32_bf16 v[80:83], v[112:115], v[116:119], v[80:83]
    v_mfma_f32_16x16x32_bf16 v[84:87], v[112:115], v[120:123], v[84:87]
    v_mfma_f32_16x16x32_bf16 v[88:91], v[112:115], v[124:127], v[88:91]
    v_mfma_f32_16x16x32_bf16 v[92:95], v[112:115], v[128:131], v[92:95]
    global_load_dwordx4 v[96:99], v4, s[8:9]
    global_load_dwordx4 v[100:103], v5, s[8:9]
    global_load_dwordx4 v[104:107], v6, s[8:9]
    global_load_dwordx4 v[108:111], v7, s[8:9]
    global_load_dwordx4 v[112:115], v8, s[8:9]
    global_load_dwordx4 v[116:119], v9, s[10:11]
    global_load_dwordx4 v[120:123], v10, s[10:11]
    global_load_dwordx4 v[124:127], v11, s[10:11]
    global_load_dwordx4 v[128:131], v12, s[10:11]
    s_add_u32 s8, s8, 4096
    s_addc_u32 s9, s9, 0
    s_add_u32 s10, s10, 4096
    s_addc_u32 s11, s11, 0
    s_waitcnt vmcnt(27)
    v_mfma_f32_16x16x32_bf16 v[16:19], v[132:135], v[152:155], v[16:19]
    v_mfma_f32_16x16x32_bf16 v[20:23], v[132:135], v[156:159], v[20:23]
    v_mfma_f32_16x16x32_bf16 v[24:27], v[132:135], v[160:163], v[24:27]
    v_mfma_f32_16x16x32_bf16 v[28:31], v[132:135], v[164:167], v[28:31]
    v_mfma_f32_16x16x32_bf16 v[32:35], v[136:139], v[152:155], v[32:35]
    v_mfma_f32_16x16x32_bf16 v[36:39], v[136:139], v[156:159], v[36:39]
    v_mfma_f32_16x16x32_bf16 v[40:43], v[136:139], v[160:163], v[40:43]
    v_mfma_f32_16x16x32_bf16 v[44:47], v[136:139], v[164:167], v[44:47]
    v_mfma_f32_16x16x32_bf16 v[48:51], v[140:143], v[152:155], v[48:51]
    v_mfma_f32_16x16x32_bf16 v[52:55], v[140:143], v[156:159], v[52:55]
    v_mfma_f32_16x16x32_bf16 v[56:59], v[140:143], v[160:163], v[56:59]
    v_mfma_f32_16x16x32_bf16 v[60:63], v[140:143], v[164:167], v[60:63]
    v_mfma_f32_16x16x32_bf16 v[64:67], v[144:147], v[152:155], v[64:67]
    v_mfma_f32_16x16x32_bf16 v[68:71], v[144:147], v[156:159], v[68:71]
    v_mfma_f32_16x16x32_bf16 v[72:75], v[144:147], v[160:163], v[72:75]
    v_mfma_f32_16x16x32_bf16 v[76:79], v[144:147], v[164:167], v[76:79]
    v_mfma_f32_16x16x32_bf16 v[80:83], v[148:151], v[152:155], v[80:83]
    v_mfma_f32_16x16x32_bf16 v[84:87], v[148:151], v[156:159], v[84:87]
    v_mfma_f32_16x16x32_bf16 v[88:91], v[148:151], v[160:163], v[88:91]
    v_mfma_f32_16x16x32_bf16 v[92:95], v[148:151], v[164:167], v[92:95]
    global_load_dwordx4 v[132:135], v4, s[8:9]
    global_load_dwordx4 v[136:139], v5, s[8:9]
    global_load_dwordx4 v[140:143], v6, s[8:9]
    global_load_dwordx4 v[144:147], v7, s[8:9]
    global_load_dwordx4 v[148:151], v8, s[8:9]
    global_load_dwordx4 v[152:155], v9, s[10:11]
    global_load_dwordx4 v[156:159], v10, s[10:11]
    global_load_dwordx4 v[160:163], v11, s[10:11]
    global_load_dwordx4 v[164:167], v12, s[10:11]
    s_add_u32 s8, s8, 4096
    s_addc_u32 s9, s9, 0
    s_add_u32 s10, s10, 4096
    s_addc_u32 s11, s11, 0
    s_waitcnt vmcnt(27)
    v_mfma_f32_16x16x32_bf16 v[16:19], v[168:171], v[188:191], v[16:19]
    v_mfma_f32_16x16x32_bf16 v[20:23], v[168:171], v[192:195], v[20:23]
    v_mfma_f32_16x16x32_bf16 v[24:27], v[168:171], v[196:199], v[24:27]
    v_mfma_f32_16x16x32_bf16 v[28:31], v[168:171], v[200:203], v[28:31]
    v_mfma_f32_16x16x32_bf16 v[32:35], v[172:175], v[188:191], v[32:35]
    v_mfma_f32_16x16x32_bf16 v[36:39], v[172:175], v[192:195], v[36:39]
    v_mfma_f32_16x16x32_bf16 v[40:43], v[172:175], v[196:199], v[40:43]
    v_mfma_f32_16x16x32_bf16 v[44:47], v[172:175], v[200:203], v[44:47]
    v_mfma_f32_16x16x32_bf16 v[48:51], v[176:179], v[188:191], v[48:51]
    v_mfma_f32_16x16x32_bf16 v[52:55], v[176:179], v[192:195], v[52:55]
    v_mfma_f32_16x16x32_bf16 v[56:59], v[176:179], v[196:199], v[56:59]
    v_mfma_f32_16x16x32_bf16 v[60:63], v[176:179], v[200:203], v[60:63]
    v_mfma_f32_16x16x32_bf16 v[64:67], v[180:183], v[188:191], v[64:67]
    v_mfma_f32_16x16x32_bf16 v[68:71], v[180:183], v[192:195], v[68:71]
    v_mfma_f32_16x16x32_bf16 v[72:75], v[180:183], v[196:199], v[72:75]
    v_mfma_f32_16x16x32_bf16 v[76:79], v[180:183], v[200:203], v[76:79]
    v_mfma_f32_16x16x32_bf16 v[80:83], v[184:187], v[188:191], v[80:83]
    v_mfma_f32_16x16x32_bf16 v[84:87], v[184:187], v[192:195], v[84:87]
    v_mfma_f32_16x16x32_bf16 v[88:91], v[184:187], v[196:199], v[88:91]
    v_mfma_f32_16x16x32_bf16 v[92:95], v[184:187], v[200:203], v[92:95]
    global_load_dwordx4 v[168:171], v4, s[8:9]
    global_load_dwordx4 v[172:175], v5, s[8:9]
    global_load_dwordx4 v[176:179], v6, s[8:9]
    global_load_dwordx4 v[180:183], v7, s[8:9]
    global_load_dwordx4 v[184:187], v8, s[8:9]
    global_load_dwordx4 v[188:191], v9, s[10:11]
    global_load_dwordx4 v[192:195], v10, s[10:11]
    global_load_dwordx4 v[196:199], v11, s[10:11]
    global_load_dwordx4 v[200:203], v12, s[10:11]
    s_add_u32 s8, s8, 4096
    s_addc_u32 s9, s9, 0
    s_add_u32 s10, s10, 4096
    s_addc_u32 s11, s11, 0
    s_waitcnt vmcnt(27)
    v_mfma_f32_16x16x32_bf16 v[16:19], v[204:207], v[224:227], v[16:19]
    v_mfma_f32_16x16x32_bf16 v[20:23], v[204:207], v[228:231], v[20:23]
    v_mfma_f32_16x16x32_bf16 v[24:27], v[204:207], v[232:235], v[24:27]
    v_mfma_f32_16x16x32_bf16 v[28:31], v[204:207], v[236:239], v[28:31]
    v_mfma_f32_16x16x32_bf16 v[32:35], v[208:211], v[224:227], v[32:35]
    v_mfma_f32_16x16x32_bf16 v[36:39], v[208:211], v[228:231], v[36:39]
    v_mfma_f32_16x16x32_bf16 v[40:43], v[208:211], v[232:235], v[40:43]
    v_mfma_f32_16x16x32_bf16 v[44:47], v[208:211], v[236:239], v[44:47]
    v_mfma_f32_16x16x32_bf16 v[48:51], v[212:215], v[224:227], v[48:51]
    v_mfma_f32_16x16x32_bf16 v[52:55], v[212:215], v[228:231], v[52:55]
    v_mfma_f32_16x16x32_bf16 v[56:59], v[212:215], v[232:235], v[56:59]
    v_mfma_f32_16x16x32_bf16 v[60:63], v[212:215], v[236:239], v[60:63]
    v_mfma_f32_16x16x32_bf16 v[64:67], v[216:219], v[224:227], v[64:67]
    v_mfma_f32_16x16x32_bf16 v[68:71], v[216:219], v[228:231], v[68:71]
    v_mfma_f32_16x16x32_bf16 v[72:75], v[216:219], v[232:235], v[72:75]
    v_mfma_f32_16x16x32_bf16 v[76:79], v[216:219], v[236:239], v[76:79]
    v_mfma_f32_16x16x32_bf16 v[80:83], v[220:223], v[224:227], v[80:83]
    v_mfma_f32_16x16x32_bf16 v[84:87], v[220:223], v[228:231], v[84:87]
    v_mfma_f32_16x16x32_bf16 v[88:91], v[220:223], v[232:235], v[88:91]
    v_mfma_f32_16x16x32_bf16 v[92:95], v[220:223], v[236:239], v[92:95]
    global_load_dwordx4 v[204:207], v4, s[8:9]
    global_load_dwordx4 v[208:211], v5, s[8:9]
    global_load_dwordx4 v[212:215], v6, s[8:9]
    global_load_dwordx4 v[216:219], v7, s[8:9]
    global_load_dwordx4 v[220:223], v8, s[8:9]
    global_load_dwordx4 v[224:227], v9, s[10:11]
    global_load_dwordx4 v[228:231], v10, s[10:11]
    global_load_dwordx4 v[232:235], v11, s[10:11]
    global_load_dwordx4 v[236:239], v12, s[10:11]
    s_add_u32 s8, s8, 4096
    s_addc_u32 s9, s9, 0
    s_add_u32 s10, s10, 4096
    s_addc_u32 s11, s11, 0
    s_waitcnt vmcnt(27)
    v_mfma_f32_16x16x32_bf16 v[16:19], v[96:99], v[116:119], v[16:19]
    v_mfma_f32_16x16x32_bf16 v[20:23], v[96:99], v[120:123], v[20:23]
    v_mfma_f32_16x16x32_bf16 v[24:27], v[96:99], v[124:127], v[24:27]
    v_mfma_f32_16x16x32_bf16 v[28:31], v[96:99], v[128:131], v[28:31]
    v_mfma_f32_16x16x32_bf16 v[32:35], v[100:103], v[116:119], v[32:35]
    v_mfma_f32_16x16x32_bf16 v[36:39], v[100:103], v[120:123], v[36:39]
    v_mfma_f32_16x16x32_bf16 v[40:43], v[100:103], v[124:127], v[40:43]
    v_mfma_f32_16x16x32_bf16 v[44:47], v[100:103], v[128:131], v[44:47]
    v_mfma_f32_16x16x32_bf16 v[48:51], v[104:107], v[116:119], v[48:51]
    v_mfma_f32_16x16x32_bf16 v[52:55], v[104:107], v[120:123], v[52:55]
    v_mfma_f32_16x16x32_bf16 v[56:59], v[104:107], v[124:127], v[56:59]
    v_mfma_f32_16x16x32_bf16 v[60:63], v[104:107], v[128:131], v[60:63]
    v_mfma_f32_16x16x32_bf16 v[64:67], v[108:111], v[116:119], v[64:67]
    v_mfma_f32_16x16x32_bf16 v[68:71], v[108:111], v[120:123], v[68:71]
    v_mfma_f32_16x16x32_bf16 v[72:75], v[108:111], v[124:127], v[72:75]
    v_mfma_f32_16x16x32_bf16 v[76:79], v[108:111], v[128:131], v[76:79]
    v_mfma_f32_16x16x32_bf16 v[80:83], v[112:115], v[116:119], v[80:83]
    v_mfma_f32_16x16x32_bf16 v[84:87], v[112:115], v[120:123], v[84:87]
    v_mfma_f32_16x16x32_bf16 v[88:91], v[112:115], v[124:127], v[88:91]
    v_mfma_f32_16x16x32_bf16 v[92:95], v[112:115], v[128:131], v[92:95]
    global_load_dwordx4 v[96:99], v4, s[8:9]
    global_load_dwordx4 v[100:103], v5, s[8:9]
    global_load_dwordx4 v[104:107], v6, s[8:9]
    global_load_dwordx4 v[108:111], v7, s[8:9]
    global_load_dwordx4 v[112:115], v8, s[8:9]
    global_load_dwordx4 v[116:119], v9, s[10:11]
    global_load_dwordx4 v[120:123], v10, s[10:11]
    global_load_dwordx4 v[124:127], v11, s[10:11]
    global_load_dwordx4 v[128:131], v12, s[10:11]
    s_add_u32 s8, s8, 4096
    s_addc_u32 s9, s9, 0
    s_add_u32 s10, s10, 4096
    s_addc_u32 s11, s11, 0
    s_waitcnt vmcnt(27)
    v_mfma_f32_16x16x32_bf16 v[16:19], v[132:135], v[152:155], v[16:19]
    v_mfma_f32_16x16x32_bf16 v[20:23], v[132:135], v[156:159], v[20:23]
    v_mfma_f32_16x16x32_bf16 v[24:27], v[132:135], v[160:163], v[24:27]
    v_mfma_f32_16x16x32_bf16 v[28:31], v[132:135], v[164:167], v[28:31]
    v_mfma_f32_16x16x32_bf16 v[32:35], v[136:139], v[152:155], v[32:35]
    v_mfma_f32_16x16x32_bf16 v[36:39], v[136:139], v[156:159], v[36:39]
    v_mfma_f32_16x16x32_bf16 v[40:43], v[136:139], v[160:163], v[40:43]
    v_mfma_f32_16x16x32_bf16 v[44:47], v[136:139], v[164:167], v[44:47]
    v_mfma_f32_16x16x32_bf16 v[48:51], v[140:143], v[152:155], v[48:51]
    v_mfma_f32_16x16x32_bf16 v[52:55], v[140:143], v[156:159], v[52:55]
    v_mfma_f32_16x16x32_bf16 v[56:59], v[140:143], v[160:163], v[56:59]
    v_mfma_f32_16x16x32_bf16 v[60:63], v[140:143], v[164:167], v[60:63]
    v_mfma_f32_16x16x32_bf16 v[64:67], v[144:147], v[152:155], v[64:67]
    v_mfma_f32_16x16x32_bf16 v[68:71], v[144:147], v[156:159], v[68:71]
    v_mfma_f32_16x16x32_bf16 v[72:75], v[144:147], v[160:163], v[72:75]
    v_mfma_f32_16x16x32_bf16 v[76:79], v[144:147], v[164:167], v[76:79]
    v_mfma_f32_16x16x32_bf16 v[80:83], v[148:151], v[152:155], v[80:83]
    v_mfma_f32_16x16x32_bf16 v[84:87], v[148:151], v[156:159], v[84:87]
    v_mfma_f32_16x16x32_bf16 v[88:91], v[148:151], v[160:163], v[88:91]
    v_mfma_f32_16x16x32_bf16 v[92:95], v[148:151], v[164:167], v[92:95]
    global_load_dwordx4 v[132:135], v4, s[8:9]
    global_load_dwordx4 v[136:139], v5, s[8:9]
    global_load_dwordx4 v[140:143], v6, s[8:9]
    global_load_dwordx4 v[144:147], v7, s[8:9]
    global_load_dwordx4 v[148:151], v8, s[8:9]
    global_load_dwordx4 v[152:155], v9, s[10:11]
    global_load_dwordx4 v[156:159], v10, s[10:11]
    global_load_dwordx4 v[160:163], v11, s[10:11]
    global_load_dwordx4 v[164:167], v12, s[10:11]
    s_add_u32 s8, s8, 4096
    s_addc_u32 s9, s9, 0
    s_add_u32 s10, s10, 4096
    s_addc_u32 s11, s11, 0
    s_waitcnt vmcnt(27)
    v_mfma_f32_16x16x32_bf16 v[16:19], v[168:171], v[188:191], v[16:19]
    v_mfma_f32_16x16x32_bf16 v[20:23], v[168:171], v[192:195], v[20:23]
    v_mfma_f32_16x16x32_bf16 v[24:27], v[168:171], v[196:199], v[24:27]
    v_mfma_f32_16x16x32_bf16 v[28:31], v[168:171], v[200:203], v[28:31]
    v_mfma_f32_16x16x32_bf16 v[32:35], v[172:175], v[188:191], v[32:35]
    v_mfma_f32_16x16x32_bf16 v[36:39], v[172:175], v[192:195], v[36:39]
    v_mfma_f32_16x16x32_bf16 v[40:43], v[172:175], v[196:199], v[40:43]
    v_mfma_f32_16x16x32_bf16 v[44:47], v[172:175], v[200:203], v[44:47]
    v_mfma_f32_16x16x32_bf16 v[48:51], v[176:179], v[188:191], v[48:51]
    v_mfma_f32_16x16x32_bf16 v[52:55], v[176:179], v[192:195], v[52:55]
    v_mfma_f32_16x16x32_bf16 v[56:59], v[176:179], v[196:199], v[56:59]
    v_mfma_f32_16x16x32_bf16 v[60:63], v[176:179], v[200:203], v[60:63]
    v_mfma_f32_16x16x32_bf16 v[64:67], v[180:183], v[188:191], v[64:67]
    v_mfma_f32_16x16x32_bf16 v[68:71], v[180:183], v[192:195], v[68:71]
    v_mfma_f32_16x16x32_bf16 v[72:75], v[180:183], v[196:199], v[72:75]
    v_mfma_f32_16x16x32_bf16 v[76:79], v[180:183], v[200:203], v[76:79]
    v_mfma_f32_16x16x32_bf16 v[80:83], v[184:187], v[188:191], v[80:83]
    v_mfma_f32_16x16x32_bf16 v[84:87], v[184:187], v[192:195], v[84:87]
    v_mfma_f32_16x16x32_bf16 v[88:91], v[184:187], v[196:199], v[88:91]
    v_mfma_f32_16x16x32_bf16 v[92:95], v[184:187], v[200:203], v[92:95]
    global_load_dwordx4 v[168:171], v4, s[8:9]
    global_load_dwordx4 v[172:175], v5, s[8:9]
    global_load_dwordx4 v[176:179], v6, s[8:9]
    global_load_dwordx4 v[180:183], v7, s[8:9]
    global_load_dwordx4 v[184:187], v8, s[8:9]
    global_load_dwordx4 v[188:191], v9, s[10:11]
    global_load_dwordx4 v[192:195], v10, s[10:11]
    global_load_dwordx4 v[196:199], v11, s[10:11]
    global_load_dwordx4 v[200:203], v12, s[10:11]
    s_add_u32 s8, s8, 4096
    s_addc_u32 s9, s9, 0
    s_add_u32 s10, s10, 4096
    s_addc_u32 s11, s11, 0
    s_waitcnt vmcnt(27)
    v_mfma_f32_16x16x32_bf16 v[16:19], v[204:207], v[224:227], v[16:19]
    v_mfma_f32_16x16x32_bf16 v[20:23], v[204:207], v[228:231], v[20:23]
    v_mfma_f32_16x16x32_bf16 v[24:27], v[204:207], v[232:235], v[24:27]
    v_mfma_f32_16x16x32_bf16 v[28:31], v[204:207], v[236:239], v[28:31]
    v_mfma_f32_16x16x32_bf16 v[32:35], v[208:211], v[224:227], v[32:35]
    v_mfma_f32_16x16x32_bf16 v[36:39], v[208:211], v[228:231], v[36:39]
    v_mfma_f32_16x16x32_bf16 v[40:43], v[208:211], v[232:235], v[40:43]
    v_mfma_f32_16x16x32_bf16 v[44:47], v[208:211], v[236:239], v[44:47]
    v_mfma_f32_16x16x32_bf16 v[48:51], v[212:215], v[224:227], v[48:51]
    v_mfma_f32_16x16x32_bf16 v[52:55], v[212:215], v[228:231], v[52:55]
    v_mfma_f32_16x16x32_bf16 v[56:59], v[212:215], v[232:235], v[56:59]
    v_mfma_f32_16x16x32_bf16 v[60:63], v[212:215], v[236:239], v[60:63]
    v_mfma_f32_16x16x32_bf16 v[64:67], v[216:219], v[224:227], v[64:67]
    v_mfma_f32_16x16x32_bf16 v[68:71], v[216:219], v[228:231], v[68:71]
    v_mfma_f32_16x16x32_bf16 v[72:75], v[216:219], v[232:235], v[72:75]
    v_mfma_f32_16x16x32_bf16 v[76:79], v[216:219], v[236:239], v[76:79]
    v_mfma_f32_16x16x32_bf16 v[80:83], v[220:223], v[224:227], v[80:83]
    v_mfma_f32_16x16x32_bf16 v[84:87], v[220:223], v[228:231], v[84:87]
    v_mfma_f32_16x16x32_bf16 v[88:91], v[220:223], v[232:235], v[88:91]
    v_mfma_f32_16x16x32_bf16 v[92:95], v[220:223], v[236:239], v[92:95]
    global_load_dwordx4 v[204:207], v4, s[8:9]
    global_load_dwordx4 v[208:211], v5, s[8:9]
    global_load_dwordx4 v[212:215], v6, s[8:9]
    global_load_dwordx4 v[216:219], v7, s[8:9]
    global_load_dwordx4 v[220:223], v8, s[8:9]
    global_load_dwordx4 v[224:227], v9, s[10:11]
    global_load_dwordx4 v[228:231], v10, s[10:11]
    global_load_dwordx4 v[232:235], v11, s[10:11]
    global_load_dwordx4 v[236:239], v12, s[10:11]
    s_add_u32 s8, s8, 4096
    s_addc_u32 s9, s9, 0
    s_add_u32 s10, s10, 4096
    s_addc_u32 s11, s11, 0
    s_waitcnt vmcnt(27)
    v_mfma_f32_16x16x32_bf16 v[16:19], v[96:99], v[116:119], v[16:19]
    v_mfma_f32_16x16x32_bf16 v[20:23], v[96:99], v[120:123], v[20:23]
    v_mfma_f32_16x16x32_bf16 v[24:27], v[96:99], v[124:127], v[24:27]
    v_mfma_f32_16x16x32_bf16 v[28:31], v[96:99], v[128:131], v[28:31]
    v_mfma_f32_16x16x32_bf16 v[32:35], v[100:103], v[116:119], v[32:35]
    v_mfma_f32_16x16x32_bf16 v[36:39], v[100:103], v[120:123], v[36:39]
    v_mfma_f32_16x16x32_bf16 v[40:43], v[100:103], v[124:127], v[40:43]
    v_mfma_f32_16x16x32_bf16 v[44:47], v[100:103], v[128:131], v[44:47]
    v_mfma_f32_16x16x32_bf16 v[48:51], v[104:107], v[116:119], v[48:51]
    v_mfma_f32_16x16x32_bf16 v[52:55], v[104:107], v[120:123], v[52:55]
    v_mfma_f32_16x16x32_bf16 v[56:59], v[104:107], v[124:127], v[56:59]
    v_mfma_f32_16x16x32_bf16 v[60:63], v[104:107], v[128:131], v[60:63]
    v_mfma_f32_16x16x32_bf16 v[64:67], v[108:111], v[116:119], v[64:67]
    v_mfma_f32_16x16x32_bf16 v[68:71], v[108:111], v[120:123], v[68:71]
    v_mfma_f32_16x16x32_bf16 v[72:75], v[108:111], v[124:127], v[72:75]
    v_mfma_f32_16x16x32_bf16 v[76:79], v[108:111], v[128:131], v[76:79]
    v_mfma_f32_16x16x32_bf16 v[80:83], v[112:115], v[116:119], v[80:83]
    v_mfma_f32_16x16x32_bf16 v[84:87], v[112:115], v[120:123], v[84:87]
    v_mfma_f32_16x16x32_bf16 v[88:91], v[112:115], v[124:127], v[88:91]
    v_mfma_f32_16x16x32_bf16 v[92:95], v[112:115], v[128:131], v[92:95]
    global_load_dwordx4 v[96:99], v4, s[8:9]
    global_load_dwordx4 v[100:103], v5, s[8:9]
    global_load_dwordx4 v[104:107], v6, s[8:9]
    global_load_dwordx4 v[108:111], v7, s[8:9]
    global_load_dwordx4 v[112:115], v8, s[8:9]
    global_load_dwordx4 v[116:119], v9, s[10:11]
    global_load_dwordx4 v[120:123], v10, s[10:11]
    global_load_dwordx4 v[124:127], v11, s[10:11]
    global_load_dwordx4 v[128:131], v12, s[10:11]
    s_add_u32 s8, s8, 4096
    s_addc_u32 s9, s9, 0
    s_add_u32 s10, s10, 4096
    s_addc_u32 s11, s11, 0
    s_waitcnt vmcnt(27)
    v_mfma_f32_16x16x32_bf16 v[16:19], v[132:135], v[152:155], v[16:19]
    v_mfma_f32_16x16x32_bf16 v[20:23], v[132:135], v[156:159], v[20:23]
    v_mfma_f32_16x16x32_bf16 v[24:27], v[132:135], v[160:163], v[24:27]
    v_mfma_f32_16x16x32_bf16 v[28:31], v[132:135], v[164:167], v[28:31]
    v_mfma_f32_16x16x32_bf16 v[32:35], v[136:139], v[152:155], v[32:35]
    v_mfma_f32_16x16x32_bf16 v[36:39], v[136:139], v[156:159], v[36:39]
    v_mfma_f32_16x16x32_bf16 v[40:43], v[136:139], v[160:163], v[40:43]
    v_mfma_f32_16x16x32_bf16 v[44:47], v[136:139], v[164:167], v[44:47]
    v_mfma_f32_16x16x32_bf16 v[48:51], v[140:143], v[152:155], v[48:51]
    v_mfma_f32_16x16x32_bf16 v[52:55], v[140:143], v[156:159], v[52:55]
    v_mfma_f32_16x16x32_bf16 v[56:59], v[140:143], v[160:163], v[56:59]
    v_mfma_f32_16x16x32_bf16 v[60:63], v[140:143], v[164:167], v[60:63]
    v_mfma_f32_16x16x32_bf16 v[64:67], v[144:147], v[152:155], v[64:67]
    v_mfma_f32_16x16x32_bf16 v[68:71], v[144:147], v[156:159], v[68:71]
    v_mfma_f32_16x16x32_bf16 v[72:75], v[144:147], v[160:163], v[72:75]
    v_mfma_f32_16x16x32_bf16 v[76:79], v[144:147], v[164:167], v[76:79]
    v_mfma_f32_16x16x32_bf16 v[80:83], v[148:151], v[152:155], v[80:83]
    v_mfma_f32_16x16x32_bf16 v[84:87], v[148:151], v[156:159], v[84:87]
    v_mfma_f32_16x16x32_bf16 v[88:91], v[148:151], v[160:163], v[88:91]
    v_mfma_f32_16x16x32_bf16 v[92:95], v[148:151], v[164:167], v[92:95]
    global_load_dwordx4 v[132:135], v4, s[8:9]
    global_load_dwordx4 v[136:139], v5, s[8:9]
    global_load_dwordx4 v[140:143], v6, s[8:9]
    global_load_dwordx4 v[144:147], v7, s[8:9]
    global_load_dwordx4 v[148:151], v8, s[8:9]
    global_load_dwordx4 v[152:155], v9, s[10:11]
    global_load_dwordx4 v[156:159], v10, s[10:11]
    global_load_dwordx4 v[160:163], v11, s[10:11]
    global_load_dwordx4 v[164:167], v12, s[10:11]
    s_add_u32 s8, s8, 4096
    s_addc_u32 s9, s9, 0
    s_add_u32 s10, s10, 4096
    s_addc_u32 s11, s11, 0
    s_waitcnt vmcnt(27)
    v_mfma_f32_16x16x32_bf16 v[16:19], v[168:171], v[188:191], v[16:19]
    v_mfma_f32_16x16x32_bf16 v[20:23], v[168:171], v[192:195], v[20:23]
    v_mfma_f32_16x16x32_bf16 v[24:27], v[168:171], v[196:199], v[24:27]
    v_mfma_f32_16x16x32_bf16 v[28:31], v[168:171], v[200:203], v[28:31]
    v_mfma_f32_16x16x32_bf16 v[32:35], v[172:175], v[188:191], v[32:35]
    v_mfma_f32_16x16x32_bf16 v[36:39], v[172:175], v[192:195], v[36:39]
    v_mfma_f32_16x16x32_bf16 v[40:43], v[172:175], v[196:199], v[40:43]
    v_mfma_f32_16x16x32_bf16 v[44:47], v[172:175], v[200:203], v[44:47]
    v_mfma_f32_16x16x32_bf16 v[48:51], v[176:179], v[188:191], v[48:51]
    v_mfma_f32_16x16x32_bf16 v[52:55], v[176:179], v[192:195], v[52:55]
    v_mfma_f32_16x16x32_bf16 v[56:59], v[176:179], v[196:199], v[56:59]
    v_mfma_f32_16x16x32_bf16 v[60:63], v[176:179], v[200:203], v[60:63]
    v_mfma_f32_16x16x32_bf16 v[64:67], v[180:183], v[188:191], v[64:67]
    v_mfma_f32_16x16x32_bf16 v[68:71], v[180:183], v[192:195], v[68:71]
    v_mfma_f32_16x16x32_bf16 v[72:75], v[180:183], v[196:199], v[72:75]
    v_mfma_f32_16x16x32_bf16 v[76:79], v[180:183], v[200:203], v[76:79]
    v_mfma_f32_16x16x32_bf16 v[80:83], v[184:187], v[188:191], v[80:83]
    v_mfma_f32_16x16x32_bf16 v[84:87], v[184:187], v[192:195], v[84:87]
    v_mfma_f32_16x16x32_bf16 v[88:91], v[184:187], v[196:199], v[88:91]
    v_mfma_f32_16x16x32_bf16 v[92:95], v[184:187], v[200:203], v[92:95]
    s_waitcnt vmcnt(18)
    v_mfma_f32_16x16x32_bf16 v[16:19], v[204:207], v[224:227], v[16:19]
    v_mfma_f32_16x16x32_bf16 v[20:23], v[204:207], v[228:231], v[20:23]
    v_mfma_f32_16x16x32_bf16 v[24:27], v[204:207], v[232:235], v[24:27]
    v_mfma_f32_16x16x32_bf16 v[28:31], v[204:207], v[236:239], v[28:31]
    v_mfma_f32_16x16x32_bf16 v[32:35], v[208:211], v[224:227], v[32:35]
    v_mfma_f32_16x16x32_bf16 v[36:39], v[208:211], v[228:231], v[36:39]
    v_mfma_f32_16x16x32_bf16 v[40:43], v[208:211], v[232:235], v[40:43]
    v_mfma_f32_16x16x32_bf16 v[44:47], v[208:211], v[236:239], v[44:47]
    v_mfma_f32_16x16x32_bf16 v[48:51], v[212:215], v[224:227], v[48:51]
    v_mfma_f32_16x16x32_bf16 v[52:55], v[212:215], v[228:231], v[52:55]
    v_mfma_f32_16x16x32_bf16 v[56:59], v[212:215], v[232:235], v[56:59]
    v_mfma_f32_16x16x32_bf16 v[60:63], v[212:215], v[236:239], v[60:63]
    v_mfma_f32_16x16x32_bf16 v[64:67], v[216:219], v[224:227], v[64:67]
    v_mfma_f32_16x16x32_bf16 v[68:71], v[216:219], v[228:231], v[68:71]
    v_mfma_f32_16x16x32_bf16 v[72:75], v[216:219], v[232:235], v[72:75]
    v_mfma_f32_16x16x32_bf16 v[76:79], v[216:219], v[236:239], v[76:79]
    v_mfma_f32_16x16x32_bf16 v[80:83], v[220:223], v[224:227], v[80:83]
    v_mfma_f32_16x16x32_bf16 v[84:87], v[220:223], v[228:231], v[84:87]
    v_mfma_f32_16x16x32_bf16 v[88:91], v[220:223], v[232:235], v[88:91]
    v_mfma_f32_16x16x32_bf16 v[92:95], v[220:223], v[236:239], v[92:95]
    s_waitcnt vmcnt(9)
    v_mfma_f32_16x16x32_bf16 v[16:19], v[96:99], v[116:119], v[16:19]
    v_mfma_f32_16x16x32_bf16 v[20:23], v[96:99], v[120:123], v[20:23]
    v_mfma_f32_16x16x32_bf16 v[24:27], v[96:99], v[124:127], v[24:27]
    v_mfma_f32_16x16x32_bf16 v[28:31], v[96:99], v[128:131], v[28:31]
    v_mfma_f32_16x16x32_bf16 v[32:35], v[100:103], v[116:119], v[32:35]
    v_mfma_f32_16x16x32_bf16 v[36:39], v[100:103], v[120:123], v[36:39]
    v_mfma_f32_16x16x32_bf16 v[40:43], v[100:103], v[124:127], v[40:43]
    v_mfma_f32_16x16x32_bf16 v[44:47], v[100:103], v[128:131], v[44:47]
    v_mfma_f32_16x16x32_bf16 v[48:51], v[104:107], v[116:119], v[48:51]
    v_mfma_f32_16x16x32_bf16 v[52:55], v[104:107], v[120:123], v[52:55]
    v_mfma_f32_16x16x32_bf16 v[56:59], v[104:107], v[124:127], v[56:59]
    v_mfma_f32_16x16x32_bf16 v[60:63], v[104:107], v[128:131], v[60:63]
    v_mfma_f32_16x16x32_bf16 v[64:67], v[108:111], v[116:119], v[64:67]
    v_mfma_f32_16x16x32_bf16 v[68:71], v[108:111], v[120:123], v[68:71]
    v_mfma_f32_16x16x32_bf16 v[72:75], v[108:111], v[124:127], v[72:75]
    v_mfma_f32_16x16x32_bf16 v[76:79], v[108:111], v[128:131], v[76:79]
    v_mfma_f32_16x16x32_bf16 v[80:83], v[112:115], v[116:119], v[80:83]
    v_mfma_f32_16x16x32_bf16 v[84:87], v[112:115], v[120:123], v[84:87]
    v_mfma_f32_16x16x32_bf16 v[88:91], v[112:115], v[124:127], v[88:91]
    v_mfma_f32_16x16x32_bf16 v[92:95], v[112:115], v[128:131], v[92:95]
    s_waitcnt vmcnt(0)
    v_mfma_f32_16x16x32_bf16 v[16:19], v[132:135], v[152:155], v[16:19]
    v_mfma_f32_16x16x32_bf16 v[20:23], v[132:135], v[156:159], v[20:23]
    v_mfma_f32_16x16x32_bf16 v[24:27], v[132:135], v[160:163], v[24:27]
    v_mfma_f32_16x16x32_bf16 v[28:31], v[132:135], v[164:167], v[28:31]
    v_mfma_f32_16x16x32_bf16 v[32:35], v[136:139], v[152:155], v[32:35]
    v_mfma_f32_16x16x32_bf16 v[36:39], v[136:139], v[156:159], v[36:39]
    v_mfma_f32_16x16x32_bf16 v[40:43], v[136:139], v[160:163], v[40:43]
    v_mfma_f32_16x16x32_bf16 v[44:47], v[136:139], v[164:167], v[44:47]
    v_mfma_f32_16x16x32_bf16 v[48:51], v[140:143], v[152:155], v[48:51]
    v_mfma_f32_16x16x32_bf16 v[52:55], v[140:143], v[156:159], v[52:55]
    v_mfma_f32_16x16x32_bf16 v[56:59], v[140:143], v[160:163], v[56:59]
    v_mfma_f32_16x16x32_bf16 v[60:63], v[140:143], v[164:167], v[60:63]
    v_mfma_f32_16x16x32_bf16 v[64:67], v[144:147], v[152:155], v[64:67]
    v_mfma_f32_16x16x32_bf16 v[68:71], v[144:147], v[156:159], v[68:71]
    v_mfma_f32_16x16x32_bf16 v[72:75], v[144:147], v[160:163], v[72:75]
    v_mfma_f32_16x16x32_bf16 v[76:79], v[144:147], v[164:167], v[76:79]
    v_mfma_f32_16x16x32_bf16 v[80:83], v[148:151], v[152:155], v[80:83]
    v_mfma_f32_16x16x32_bf16 v[84:87], v[148:151], v[156:159], v[84:87]
    v_mfma_f32_16x16x32_bf16 v[88:91], v[148:151], v[160:163], v[88:91]
    v_mfma_f32_16x16x32_bf16 v[92:95], v[148:151], v[164:167], v[92:95]
    s_cmp_ge_u32 s6, 2
    s_cbranch_scc1 L_k4_red
    global_load_dwordx4 v[168:171], v4, s[8:9]
    global_load_dwordx4 v[172:175], v5, s[8:9]
    global_load_dwordx4 v[176:179], v6, s[8:9]
    global_load_dwordx4 v[180:183], v7, s[8:9]
    global_load_dwordx4 v[184:187], v8, s[8:9]
    global_load_dwordx4 v[188:191], v9, s[10:11]
    global_load_dwordx4 v[192:195], v10, s[10:11]
    global_load_dwordx4 v[196:199], v11, s[10:11]
    global_load_dwordx4 v[200:203], v12, s[10:11]
    s_add_u32 s8, s8, 4096
    s_addc_u32 s9, s9, 0
    s_add_u32 s10, s10, 4096
    s_addc_u32 s11, s11, 0
    s_waitcnt vmcnt(0)
    v_mfma_f32_16x16x32_bf16 v[16:19], v[168:171], v[188:191], v[16:19]
    v_mfma_f32_16x16x32_bf16 v[20:23], v[168:171], v[192:195], v[20:23]
    v_mfma_f32_16x16x32_bf16 v[24:27], v[168:171], v[196:199], v[24:27]
    v_mfma_f32_16x16x32_bf16 v[28:31], v[168:171], v[200:203], v[28:31]
    v_mfma_f32_16x16x32_bf16 v[32:35], v[172:175], v[188:191], v[32:35]
    v_mfma_f32_16x16x32_bf16 v[36:39], v[172:175], v[192:195], v[36:39]
    v_mfma_f32_16x16x32_bf16 v[40:43], v[172:175], v[196:199], v[40:43]
    v_mfma_f32_16x16x32_bf16 v[44:47], v[172:175], v[200:203], v[44:47]
    v_mfma_f32_16x16x32_bf16 v[48:51], v[176:179], v[188:191], v[48:51]
    v_mfma_f32_16x16x32_bf16 v[52:55], v[176:179], v[192:195], v[52:55]
    v_mfma_f32_16x16x32_bf16 v[56:59], v[176:179], v[196:199], v[56:59]
    v_mfma_f32_16x16x32_bf16 v[60:63], v[176:179], v[200:203], v[60:63]
    v_mfma_f32_16x16x32_bf16 v[64:67], v[180:183], v[188:191], v[64:67]
    v_mfma_f32_16x16x32_bf16 v[68:71], v[180:183], v[192:195], v[68:71]
    v_mfma_f32_16x16x32_bf16 v[72:75], v[180:183], v[196:199], v[72:75]
    v_mfma_f32_16x16x32_bf16 v[76:79], v[180:183], v[200:203], v[76:79]
    v_mfma_f32_16x16x32_bf16 v[80:83], v[184:187], v[188:191], v[80:83]
    v_mfma_f32_16x16x32_bf16 v[84:87], v[184:187], v[192:195], v[84:87]
    v_mfma_f32_16x16x32_bf16 v[88:91], v[184:187], v[196:199], v[88:91]
    v_mfma_f32_16x16x32_bf16 v[92:95], v[184:187], v[200:203], v[92:95]
L_k4_red:
    s_nop 7
    s_nop 7
    s_mul_i32 s7, s6, 20480
    v_add_u32 v13, s7, v3
    ds_write_b128 v13, v[16:19] offset:0
    ds_write_b128 v13, v[20:23] offset:1024
    ds_write_b128 v13, v[24:27] offset:2048
    ds_write_b128 v13, v[28:31] offset:3072
    ds_write_b128 v13, v[32:35] offset:4096
    ds_write_b128 v13, v[36:39] offset:5120
    ds_write_b128 v13, v[40:43] offset:6144
    ds_write_b128 v13, v[44:47] offset:7168
    ds_write_b128 v13, v[48:51] offset:8192
    ds_write_b128 v13, v[52:55] offset:9216
    ds_write_b128 v13, v[56:59] offset:10240
    ds_write_b128 v13, v[60:63] offset:11264
    ds_write_b128 v13, v[64:67] offset:12288
    ds_write_b128 v13, v[68:71] offset:13312
    ds_write_b128 v13, v[72:75] offset:14336
    ds_write_b128 v13, v[76:79] offset:15360
    ds_write_b128 v13, v[80:83] offset:16384
    ds_write_b128 v13, v[84:87] offset:17408
    ds_write_b128 v13, v[88:91] offset:18432
    ds_write_b128 v13, v[92:95] offset:19456
    s_waitcnt lgkmcnt(0)
    s_barrier
    s_mul_i32 s7, s6, 5120
    v_add_u32 v13, s7, v3
    v_add_u32 v15, 61440, v13
    ds_read_b128 v[16:19], v13 offset:0
    ds_read_b128 v[20:23], v13 offset:20480
    ds_read_b128 v[24:27], v13 offset:40960
    ds_read_b128 v[28:31], v15 offset:0
    ds_read_b128 v[32:35], v13 offset:1024
    ds_read_b128 v[36:39], v13 offset:21504
    ds_read_b128 v[40:43], v13 offset:41984
    ds_read_b128 v[44:47], v15 offset:1024
    ds_read_b128 v[48:51], v13 offset:2048
    ds_read_b128 v[52:55], v13 offset:22528
    ds_read_b128 v[56:59], v13 offset:43008
    ds_read_b128 v[60:63], v15 offset:2048
    ds_read_b128 v[64:67], v13 offset:3072
    ds_read_b128 v[68:71], v13 offset:23552
    ds_read_b128 v[72:75], v13 offset:44032
    ds_read_b128 v[76:79], v15 offset:3072
    ds_read_b128 v[80:83], v13 offset:4096
    ds_read_b128 v[84:87], v13 offset:24576
    ds_read_b128 v[88:91], v13 offset:45056
    ds_read_b128 v[92:95], v15 offset:4096
    v_and_b32 v14, 15, v2
    v_mul_u32_u24 v14, 1280, v14
    v_lshrrev_b32 v15, 4, v2
    v_lshlrev_b32 v15, 3, v15
    v_add_u32 v14, v14, v15
    s_mul_i32 s12, s4, 81920
    s_mul_i32 s13, s5, 160
    s_add_u32 s12, s12, s13
    s_mul_i32 s13, s6, 5
    s_add_u32 s13, s13, 0
    s_lshr_b32 s14, s13, 2
    s_and_b32 s15, s13, 3
    s_lshl_b32 s14, s14, 5
    s_mul_i32 s15, s15, 20480
    s_add_u32 s14, s14, s15
    s_add_u32 s14, s14, s12
    v_add_u32 v110, s14, v14
    global_load_dwordx2 v[100:101], v110, s[20:21]
    s_mul_i32 s13, s6, 5
    s_add_u32 s13, s13, 1
    s_lshr_b32 s14, s13, 2
    s_and_b32 s15, s13, 3
    s_lshl_b32 s14, s14, 5
    s_mul_i32 s15, s15, 20480
    s_add_u32 s14, s14, s15
    s_add_u32 s14, s14, s12
    v_add_u32 v111, s14, v14
    global_load_dwordx2 v[102:103], v111, s[20:21]
    s_mul_i32 s13, s6, 5
    s_add_u32 s13, s13, 2
    s_lshr_b32 s14, s13, 2
    s_and_b32 s15, s13, 3
    s_lshl_b32 s14, s14, 5
    s_mul_i32 s15, s15, 20480
    s_add_u32 s14, s14, s15
    s_add_u32 s14, s14, s12
    v_add_u32 v112, s14, v14
    global_load_dwordx2 v[104:105], v112, s[20:21]
    s_mul_i32 s13, s6, 5
    s_add_u32 s13, s13, 3
    s_lshr_b32 s14, s13, 2
    s_and_b32 s15, s13, 3
    s_lshl_b32 s14, s14, 5
    s_mul_i32 s15, s15, 20480
    s_add_u32 s14, s14, s15
    s_add_u32 s14, s14, s12
    v_add_u32 v113, s14, v14
    global_load_dwordx2 v[106:107], v113, s[20:21]
    s_mul_i32 s13, s6, 5
    s_add_u32 s13, s13, 4
    s_lshr_b32 s14, s13, 2
    s_and_b32 s15, s13, 3
    s_lshl_b32 s14, s14, 5
    s_mul_i32 s15, s15, 20480
    s_add_u32 s14, s14, s15
    s_add_u32 s14, s14, s12
    v_add_u32 v114, s14, v14
    global_load_dwordx2 v[108:109], v114, s[20:21]
    s_waitcnt lgkmcnt(0)
    v_add_f32 v16, v16, v20
    v_add_f32 v24, v24, v28
    v_add_f32 v17, v17, v21
    v_add_f32 v25, v25, v29
    v_add_f32 v18, v18, v22
    v_add_f32 v26, v26, v30
    v_add_f32 v19, v19, v23
    v_add_f32 v27, v27, v31
    v_add_f32 v16, v16, v24
    v_add_f32 v17, v17, v25
    v_add_f32 v18, v18, v26
    v_add_f32 v19, v19, v27
    v_add_f32 v32, v32, v36
    v_add_f32 v40, v40, v44
    v_add_f32 v33, v33, v37
    v_add_f32 v41, v41, v45
    v_add_f32 v34, v34, v38
    v_add_f32 v42, v42, v46
    v_add_f32 v35, v35, v39
    v_add_f32 v43, v43, v47
    v_add_f32 v32, v32, v40
    v_add_f32 v33, v33, v41
    v_add_f32 v34, v34, v42
    v_add_f32 v35, v35, v43
    v_add_f32 v48, v48, v52
    v_add_f32 v56, v56, v60
    v_add_f32 v49, v49, v53
    v_add_f32 v57, v57, v61
    v_add_f32 v50, v50, v54
    v_add_f32 v58, v58, v62
    v_add_f32 v51, v51, v55
    v_add_f32 v59, v59, v63
    v_add_f32 v48, v48, v56
    v_add_f32 v49, v49, v57
    v_add_f32 v50, v50, v58
    v_add_f32 v51, v51, v59
    v_add_f32 v64, v64, v68
    v_add_f32 v72, v72, v76
    v_add_f32 v65, v65, v69
    v_add_f32 v73, v73, v77
    v_add_f32 v66, v66, v70
    v_add_f32 v74, v74, v78
    v_add_f32 v67, v67, v71
    v_add_f32 v75, v75, v79
    v_add_f32 v64, v64, v72
    v_add_f32 v65, v65, v73
    v_add_f32 v66, v66, v74
    v_add_f32 v67, v67, v75
    v_add_f32 v80, v80, v84
    v_add_f32 v88, v88, v92
    v_add_f32 v81, v81, v85
    v_add_f32 v89, v89, v93
    v_add_f32 v82, v82, v86
    v_add_f32 v90, v90, v94
    v_add_f32 v83, v83, v87
    v_add_f32 v91, v91, v95
    v_add_f32 v80, v80, v88
    v_add_f32 v81, v81, v89
    v_add_f32 v82, v82, v90
    v_add_f32 v83, v83, v91
    s_waitcnt vmcnt(0)
    v_lshlrev_b32 v13, 16, v100
    v_and_b32 v15, 0xffff0000, v100
    v_add_f32 v16, v16, v13
    v_add_f32 v17, v17, v15
    v_lshlrev_b32 v13, 16, v101
    v_and_b32 v15, 0xffff0000, v101
    v_add_f32 v18, v18, v13
    v_add_f32 v19, v19, v15
    v_cvt_pk_bf16_f32 v20, v16, v17
    v_cvt_pk_bf16_f32 v21, v18, v19
    global_store_dwordx2 v110, v[20:21], s[22:23]
    v_lshlrev_b32 v13, 16, v102
    v_and_b32 v15, 0xffff0000, v102
    v_add_f32 v32, v32, v13
    v_add_f32 v33, v33, v15
    v_lshlrev_b32 v13, 16, v103
    v_and_b32 v15, 0xffff0000, v103
    v_add_f32 v34, v34, v13
    v_add_f32 v35, v35, v15
    v_cvt_pk_bf16_f32 v36, v32, v33
    v_cvt_pk_bf16_f32 v37, v34, v35
    global_store_dwordx2 v111, v[36:37], s[22:23]
    v_lshlrev_b32 v13, 16, v104
    v_and_b32 v15, 0xffff0000, v104
    v_add_f32 v48, v48, v13
    v_add_f32 v49, v49, v15
    v_lshlrev_b32 v13, 16, v105
    v_and_b32 v15, 0xffff0000, v105
    v_add_f32 v50, v50, v13
    v_add_f32 v51, v51, v15
    v_cvt_pk_bf16_f32 v52, v48, v49
    v_cvt_pk_bf16_f32 v53, v50, v51
    global_store_dwordx2 v112, v[52:53], s[22:23]
    v_lshlrev_b32 v13, 16, v106
    v_and_b32 v15, 0xffff0000, v106
    v_add_f32 v64, v64, v13
    v_add_f32 v65, v65, v15
    v_lshlrev_b32 v13, 16, v107
    v_and_b32 v15, 0xffff0000, v107
    v_add_f32 v66, v66, v13
    v_add_f32 v67, v67, v15
    v_cvt_pk_bf16_f32 v68, v64, v65
    v_cvt_pk_bf16_f32 v69, v66, v67
    global_store_dwordx2 v113, v[68:69], s[22:23]
    v_lshlrev_b32 v13, 16, v108
    v_and_b32 v15, 0xffff0000, v108
    v_add_f32 v80, v80, v13
    v_add_f32 v81, v81, v15
    v_lshlrev_b32 v13, 16, v109
    v_and_b32 v15, 0xffff0000, v109
    v_add_f32 v82, v82, v13
    v_add_f32 v83, v83, v15
    v_cvt_pk_bf16_f32 v84, v80, v81
    v_cvt_pk_bf16_f32 v85, v82, v83
    global_store_dwordx2 v114, v[84:85], s[22:23]
L_k4_end:
    s_endpgm
.section .rodata,"a"
.p2align 6
.p2align 6
.amdhsa_kernel k1_prep_kernel
  .amdhsa_next_free_vgpr 96
  .amdhsa_next_free_sgpr 32
  .amdhsa_accum_offset 96
  .amdhsa_group_segment_fixed_size 0
  .amdhsa_kernarg_size 80
  .amdhsa_user_sgpr_count 2
  .amdhsa_user_sgpr_kernarg_segment_ptr 1
  .amdhsa_system_sgpr_workgroup_id_x 1
.end_amdhsa_kernel
.p2align 6
.amdhsa_kernel k2_gemm1_kernel
  .amdhsa_next_free_vgpr 144
  .amdhsa_next_free_sgpr 32
  .amdhsa_accum_offset 144
  .amdhsa_group_segment_fixed_size 0
  .amdhsa_kernarg_size 80
  .amdhsa_user_sgpr_count 2
  .amdhsa_user_sgpr_kernarg_segment_ptr 1
  .amdhsa_system_sgpr_workgroup_id_x 1
.end_amdhsa_kernel
.p2align 6
.amdhsa_kernel k3_attn_kernel
  .amdhsa_next_free_vgpr 192
  .amdhsa_next_free_sgpr 32
  .amdhsa_accum_offset 192
  .amdhsa_group_segment_fixed_size 0
  .amdhsa_kernarg_size 80
  .amdhsa_user_sgpr_count 2
  .amdhsa_user_sgpr_kernarg_segment_ptr 1
  .amdhsa_system_sgpr_workgroup_id_x 1
.end_amdhsa_kernel
.p2align 6
.amdhsa_kernel k4_gemm2_kernel
  .amdhsa_next_free_vgpr 240
  .amdhsa_next_free_sgpr 32
  .amdhsa_accum_offset 240
  .amdhsa_group_segment_fixed_size 0
  .amdhsa_kernarg_size 80
  .amdhsa_user_sgpr_count 2
  .amdhsa_user_sgpr_kernarg_segment_ptr 1
  .amdhsa_system_sgpr_workgroup_id_x 1
.end_amdhsa_kernel
```
